```python
import torch

def _softmax(x, axis=-1):
    return torch.softmax(x, dim=axis)
def _gelu(x):
    return torch.nn.functional.gelu(x, approximate="tanh")
def _silu(x):
    return torch.nn.functional.silu(x)
def _sigmoid(x):
    return torch.sigmoid(x)
def _layernorm(x, axis=-1, eps=1e-5):
    m = x.mean(dim=axis, keepdim=True)
    v = x.var(dim=axis, keepdim=True, unbiased=False)
    return (x - m) / torch.sqrt(v + eps)
def _scatter_add(tgt, idx, src, axis=0):
    return tgt.clone().index_add_(axis, idx, src)
def _segment_sum(src, seg, n):
    out = torch.zeros((n,) + src.shape[1:], dtype=src.dtype)
    return out.index_add_(0, seg, src)
def _pad(x, pw):
    flat = tuple(v for pair in reversed(pw) for v in pair)
    return torch.nn.functional.pad(x, flat)

kernel_name = 'standalone__gqa_softmax__near_ridge'

def setup_inputs():

    _w = (lambda a: (lambda t: t.to(torch.bfloat16) if t.is_floating_point() else t)(torch.as_tensor(a)))
    B, Hq, Hkv, Sq, Sk, D = 8, 32, 16, 160, 2048, 128
    return {
        "q": _w((lambda *s: torch.randn(*s, dtype=torch.bfloat16) * 0.8)(B, Hq, Sq, D)),
        "k": _w((lambda *s: torch.randn(*s, dtype=torch.bfloat16) * 0.8)(B, Hkv, Sk, D)),
        "v": _w((lambda *s: torch.randn(*s, dtype=torch.bfloat16) * 0.05)(B, Hkv, Sk, D)),
    }

def reference(q, k, v):
    B, Hq, Sq, D = q.shape
    Hkv = k.shape[1]
    rep = Hq // Hkv
    k = (lambda x, n, axis: torch.repeat_interleave(x, n, dim=axis))(k, rep, axis=1)
    v = (lambda x, n, axis: torch.repeat_interleave(x, n, dim=axis))(v, rep, axis=1)
    scale = D ** -0.5
    scores = torch.einsum("bhqd,bhkd->bhqk", q, k) * scale
    p = _softmax(scores, axis=-1)
    return torch.einsum("bhqk,bhkd->bhqd", p, v)
```

```asm
; @launch grid=(256,1,1) block=(256,1,1) lds=155648
.amdgcn_target "amdgcn-amd-amdhsa--gfx950"
.text
.globl standalone__gqa_softmax__near_ridge_kernel
.p2align 8
.type standalone__gqa_softmax__near_ridge_kernel,@function
standalone__gqa_softmax__near_ridge_kernel:
    s_cmp_ge_u32 s2, 256
    s_cbranch_scc1 L_done
    s_load_dwordx4 s[4:7], s[0:1], 0
    s_load_dwordx4 s[8:11], s[0:1], 16
    v_lshrrev_b32 v218, 6, v0
    v_and_b32 v252, 63, v0
    v_readfirstlane_b32 s3, v218
    v_and_b32 v219, 15, v252
    v_lshrrev_b32 v220, 4, v252
    s_lshr_b32 s54, s2, 4
    s_lshl_b32 s54, s54, 3
    s_and_b32 s55, s2, 7
    s_add_u32 s54, s54, s55
    s_lshr_b32 s55, s2, 3
    s_and_b32 s55, s55, 1
    s_mov_b32 s30, s55
    s_lshl_b32 s56, s54, 1
    s_add_u32 s55, s56, s55
    s_lshr_b32 s47, s3, 1
    s_and_b32 s46, s3, 1
    s_mul_i32 s55, s55, 40960
    s_mul_i32 s56, s47, 20480
    s_add_u32 s55, s55, s56
    s_lshl_b32 s54, s54, 19
    v_lshlrev_b32 v221, 1, v220
    v_xor_b32 v221, v221, v219
    v_lshlrev_b32 v221, 4, v221
    v_lshl_add_u32 v216, v220, 8, v221
    v_xor_b32 v217, 128, v216
    v_lshlrev_b32 v221, 8, v219
    v_lshl_add_u32 v253, v220, 4, v221
    s_mov_b32 s40, 0
    s_mov_b32 s41, 4096
    s_mov_b32 s42, 8192
    s_mov_b32 s43, 12288
    s_mov_b32 s44, 16384
    s_lshl_b32 s28, s3, 12
    s_add_u32 s32, s28, 0
    s_add_u32 s36, s28, 65536
    s_add_u32 s33, s28, 16384
    s_add_u32 s37, s28, 81920
    s_add_u32 s34, s28, 32768
    s_add_u32 s38, s28, 98304
    s_add_u32 s35, s28, 49152
    s_add_u32 s39, s28, 114688
    s_mov_b32 s29, s28
    s_mov_b32 m0, s32
    s_mov_b32 s22, 20480
    s_mov_b32 s23, 0x20000
    s_mov_b32 s14, 524288
    s_mov_b32 s15, 0x20000
    s_mov_b32 s18, 524288
    s_mov_b32 s19, 0x20000
    s_mov_b32 s26, 20480
    s_mov_b32 s27, 0x20000
    s_waitcnt lgkmcnt(0)
    s_add_u32 s12, s6, s54
    s_addc_u32 s13, s7, 0
    s_and_b32 s13, s13, 0xffff
    buffer_load_dwordx4 v216, s[12:15], s28 offen offset:0 nt lds
    buffer_load_dwordx4 v217, s[12:15], s28 offen offset:1024 nt lds
    buffer_load_dwordx4 v216, s[12:15], s28 offen offset:2048 nt lds
    buffer_load_dwordx4 v217, s[12:15], s28 offen offset:3072 nt lds
    s_add_u32 s20, s4, s55
    s_addc_u32 s21, s5, 0
    s_and_b32 s21, s21, 0xffff
    s_lshl_b32 s57, s46, 11
    s_mul_i32 s62, s47, 20480
    s_add_u32 s62, s62, s57
    s_add_u32 s62, s62, 114688
    s_add_u32 m0, s62, 0
    s_add_u32 s58, s57, 0
    buffer_load_dwordx4 v216, s[20:23], s58 offen offset:0 nt lds
    buffer_load_dwordx4 v217, s[20:23], s58 offen offset:1024 nt lds
    s_add_u32 m0, s62, 4096
    s_add_u32 s58, s57, 4096
    buffer_load_dwordx4 v216, s[20:23], s58 offen offset:0 nt lds
    buffer_load_dwordx4 v217, s[20:23], s58 offen offset:1024 nt lds
    s_add_u32 m0, s62, 8192
    s_add_u32 s58, s57, 8192
    buffer_load_dwordx4 v216, s[20:23], s58 offen offset:0 nt lds
    buffer_load_dwordx4 v217, s[20:23], s58 offen offset:1024 nt lds
    s_add_u32 m0, s62, 12288
    s_add_u32 s58, s57, 12288
    buffer_load_dwordx4 v216, s[20:23], s58 offen offset:0 nt lds
    buffer_load_dwordx4 v217, s[20:23], s58 offen offset:1024 nt lds
    s_add_u32 m0, s62, 16384
    s_add_u32 s58, s57, 16384
    buffer_load_dwordx4 v216, s[20:23], s58 offen offset:0 nt lds
    buffer_load_dwordx4 v217, s[20:23], s58 offen offset:1024 nt lds
    s_add_u32 s16, s8, s54
    s_addc_u32 s17, s9, 0
    s_and_b32 s17, s17, 0xffff
    s_add_u32 s24, s10, s55
    s_addc_u32 s25, s11, 0
    s_and_b32 s25, s25, 0xffff
    s_lshl_b32 s61, s46, 13
    v_and_b32 v221, 7, v219
    v_lshlrev_b32 v221, 1, v221
    v_xor_b32 v221, v221, v220
    v_lshlrev_b32 v221, 4, v221
    v_lshl_add_u32 v221, v219, 8, v221
    v_mov_b32 v226, v221
    v_xor_b32 v227, 64, v221
    v_xor_b32 v228, 128, v221
    v_xor_b32 v229, 192, v221
    v_add_u32 v204, s61, v226
    v_add_u32 v205, s61, v227
    v_add_u32 v206, s61, v228
    v_add_u32 v207, s61, v229
    v_lshrrev_b32 v221, 2, v219
    v_lshl_add_u32 v221, v220, 2, v221
    v_and_b32 v222, 7, v221
    v_lshlrev_b32 v222, 1, v222
    v_bfe_u32 v223, v219, 1, 1
    v_xor_b32 v222, v222, v223
    v_lshlrev_b32 v222, 4, v222
    v_lshl_add_u32 v222, v221, 8, v222
    v_and_b32 v223, 1, v219
    v_lshl_add_u32 v222, v223, 3, v222
    s_lshl_b32 s60, s46, 7
    s_add_u32 s54, s61, 65536
    v_add_u32 v222, s54, v222
    v_xor_b32 v208, s60, v222
    v_xor_b32 v209, 32, v208
    v_xor_b32 v210, 64, v208
    v_xor_b32 v211, 96, v208
    v_xor_b32 v212, 128, v208
    v_xor_b32 v213, 160, v208
    v_xor_b32 v214, 192, v208
    v_xor_b32 v215, 224, v208
    v_and_b32 v221, 1, v220
    v_lshlrev_b32 v221, 5, v221
    v_lshrrev_b32 v222, 1, v220
    v_lshl_add_u32 v221, v222, 4, v221
    v_lshl_add_u32 v221, v219, 8, v221
    v_add_u32 v254, s60, v221
    s_mul_i32 s55, s47, 45056
    s_add_u32 s55, s55, 20480
    s_lshl_b32 s54, s47, 16
    s_mul_i32 s56, s46, s55
    s_add_u32 s56, s56, s54
    s_lshl_b32 s54, s54, 1
    s_add_u32 s54, s54, s55
    s_sub_u32 s54, s54, s56
    v_lshlrev_b32 v221, 4, v252
    v_add_u32 v255, s56, v221
    v_add_u32 v242, s54, v221
    s_mul_i32 s55, s3, 1280
    s_add_u32 s55, s55, 40960
    v_lshlrev_b32 v221, 2, v252
    v_add_u32 v240, s55, v221
    s_xor_b32 s55, s3, 1
    s_mul_i32 s55, s55, 1280
    s_add_u32 s55, s55, 40960
    v_add_u32 v241, s55, v221
    s_mov_b32 s48, 0x3e0293ee
    s_mov_b32 s49, 0x3e0293ee
    s_mov_b32 s50, 0x4e800000
    s_mov_b32 s51, 0
    v_mov_b64 v[0:1], 0
    v_mov_b64 v[2:3], 0
    v_mov_b64 v[4:5], 0
    v_mov_b64 v[6:7], 0
    v_mov_b64 v[8:9], 0
    v_mov_b64 v[10:11], 0
    v_mov_b64 v[12:13], 0
    v_mov_b64 v[14:15], 0
    v_mov_b64 v[16:17], 0
    v_mov_b64 v[18:19], 0
    v_mov_b64 v[20:21], 0
    v_mov_b64 v[22:23], 0
    v_mov_b64 v[24:25], 0
    v_mov_b64 v[26:27], 0
    v_mov_b64 v[28:29], 0
    v_mov_b64 v[30:31], 0
    v_mov_b64 v[32:33], 0
    v_mov_b64 v[34:35], 0
    v_mov_b64 v[36:37], 0
    v_mov_b64 v[38:39], 0
    v_mov_b64 v[40:41], 0
    v_mov_b64 v[42:43], 0
    v_mov_b64 v[44:45], 0
    v_mov_b64 v[46:47], 0
    v_mov_b64 v[48:49], 0
    v_mov_b64 v[50:51], 0
    v_mov_b64 v[52:53], 0
    v_mov_b64 v[54:55], 0
    v_mov_b64 v[56:57], 0
    v_mov_b64 v[58:59], 0
    v_mov_b64 v[60:61], 0
    v_mov_b64 v[62:63], 0
    v_mov_b64 v[64:65], 0
    v_mov_b64 v[66:67], 0
    v_mov_b64 v[68:69], 0
    v_mov_b64 v[70:71], 0
    v_mov_b64 v[72:73], 0
    v_mov_b64 v[74:75], 0
    v_mov_b64 v[76:77], 0
    v_mov_b64 v[78:79], 0
    v_accvgpr_write_b32 a0, 0
    v_accvgpr_write_b32 a1, 0
    v_accvgpr_write_b32 a2, 0
    v_accvgpr_write_b32 a3, 0
    v_accvgpr_write_b32 a4, 0
    v_accvgpr_write_b32 a5, 0
    v_accvgpr_write_b32 a6, 0
    v_accvgpr_write_b32 a7, 0
    v_accvgpr_write_b32 a8, 0
    v_accvgpr_write_b32 a9, 0
    v_accvgpr_write_b32 a10, 0
    v_accvgpr_write_b32 a11, 0
    v_accvgpr_write_b32 a12, 0
    v_accvgpr_write_b32 a13, 0
    v_accvgpr_write_b32 a14, 0
    v_accvgpr_write_b32 a15, 0
    v_accvgpr_write_b32 a16, 0
    v_accvgpr_write_b32 a17, 0
    v_accvgpr_write_b32 a18, 0
    v_accvgpr_write_b32 a19, 0
    v_accvgpr_write_b32 a20, 0
    v_accvgpr_write_b32 a21, 0
    v_accvgpr_write_b32 a22, 0
    v_accvgpr_write_b32 a23, 0
    v_accvgpr_write_b32 a24, 0
    v_accvgpr_write_b32 a25, 0
    v_accvgpr_write_b32 a26, 0
    v_accvgpr_write_b32 a27, 0
    v_accvgpr_write_b32 a28, 0
    v_accvgpr_write_b32 a29, 0
    v_accvgpr_write_b32 a30, 0
    v_accvgpr_write_b32 a31, 0
    v_accvgpr_write_b32 a32, 0
    v_accvgpr_write_b32 a33, 0
    v_accvgpr_write_b32 a34, 0
    v_accvgpr_write_b32 a35, 0
    v_accvgpr_write_b32 a36, 0
    v_accvgpr_write_b32 a37, 0
    v_accvgpr_write_b32 a38, 0
    v_accvgpr_write_b32 a39, 0
    v_accvgpr_write_b32 a40, 0
    v_accvgpr_write_b32 a41, 0
    v_accvgpr_write_b32 a42, 0
    v_accvgpr_write_b32 a43, 0
    v_accvgpr_write_b32 a44, 0
    v_accvgpr_write_b32 a45, 0
    v_accvgpr_write_b32 a46, 0
    v_accvgpr_write_b32 a47, 0
    v_accvgpr_write_b32 a48, 0
    v_accvgpr_write_b32 a49, 0
    v_accvgpr_write_b32 a50, 0
    v_accvgpr_write_b32 a51, 0
    v_accvgpr_write_b32 a52, 0
    v_accvgpr_write_b32 a53, 0
    v_accvgpr_write_b32 a54, 0
    v_accvgpr_write_b32 a55, 0
    v_accvgpr_write_b32 a56, 0
    v_accvgpr_write_b32 a57, 0
    v_accvgpr_write_b32 a58, 0
    v_accvgpr_write_b32 a59, 0
    v_accvgpr_write_b32 a60, 0
    v_accvgpr_write_b32 a61, 0
    v_accvgpr_write_b32 a62, 0
    v_accvgpr_write_b32 a63, 0
    v_accvgpr_write_b32 a64, 0
    v_accvgpr_write_b32 a65, 0
    v_accvgpr_write_b32 a66, 0
    v_accvgpr_write_b32 a67, 0
    v_accvgpr_write_b32 a68, 0
    v_accvgpr_write_b32 a69, 0
    v_accvgpr_write_b32 a70, 0
    v_accvgpr_write_b32 a71, 0
    v_accvgpr_write_b32 a72, 0
    v_accvgpr_write_b32 a73, 0
    v_accvgpr_write_b32 a74, 0
    v_accvgpr_write_b32 a75, 0
    v_accvgpr_write_b32 a76, 0
    v_accvgpr_write_b32 a77, 0
    v_accvgpr_write_b32 a78, 0
    v_accvgpr_write_b32 a79, 0
    v_accvgpr_write_b32 a80, 0
    v_accvgpr_write_b32 a81, 0
    v_accvgpr_write_b32 a82, 0
    v_accvgpr_write_b32 a83, 0
    v_accvgpr_write_b32 a84, 0
    v_accvgpr_write_b32 a85, 0
    v_accvgpr_write_b32 a86, 0
    v_accvgpr_write_b32 a87, 0
    v_accvgpr_write_b32 a88, 0
    v_accvgpr_write_b32 a89, 0
    v_accvgpr_write_b32 a90, 0
    v_accvgpr_write_b32 a91, 0
    v_accvgpr_write_b32 a92, 0
    v_accvgpr_write_b32 a93, 0
    v_accvgpr_write_b32 a94, 0
    v_accvgpr_write_b32 a95, 0
    v_mov_b64 v[250:251], 0
    v_mov_b32 v221, 0x3f803f80
    v_accvgpr_write_b32 a228, v221
    v_accvgpr_write_b32 a229, v221
    v_accvgpr_write_b32 a230, v221
    v_accvgpr_write_b32 a231, v221
    s_mov_b32 m0, s36
    s_nop 0
    buffer_load_dwordx4 v216, s[16:19], s28 offen offset:0 nt lds
    buffer_load_dwordx4 v217, s[16:19], s28 offen offset:1024 nt lds
    buffer_load_dwordx4 v216, s[16:19], s28 offen offset:2048 nt lds
    buffer_load_dwordx4 v217, s[16:19], s28 offen offset:3072 nt lds
    s_mul_i32 s57, s47, 20480
    s_add_u32 s57, s57, 114688
    v_add_u32 v222, s57, v226
    v_add_u32 v223, s57, v227
    v_add_u32 v224, s57, v228
    v_add_u32 v225, s57, v229
    s_waitcnt vmcnt(12)
    s_barrier
    ds_read_b128 v[80:83], v222 offset:0
    ds_read_b128 v[84:87], v223 offset:0
    ds_read_b128 v[88:91], v224 offset:0
    ds_read_b128 v[92:95], v225 offset:0
    ds_read_b128 a[132:135], v226
    ds_read_b128 a[136:139], v227
    ds_read_b128 a[140:143], v228
    ds_read_b128 a[144:147], v229
    ds_read_b128 a[100:103], v204 offset:0
    ds_read_b128 a[104:107], v205 offset:0
    ds_read_b128 a[108:111], v206 offset:0
    ds_read_b128 a[112:115], v207 offset:0
    ds_read_b128 a[116:119], v204 offset:4096
    ds_read_b128 a[120:123], v205 offset:4096
    ds_read_b128 a[124:127], v206 offset:4096
    ds_read_b128 a[128:131], v207 offset:4096
    s_waitcnt vmcnt(10)
    s_barrier
    ds_read_b128 v[96:99], v222 offset:4096
    ds_read_b128 v[100:103], v223 offset:4096
    ds_read_b128 v[104:107], v224 offset:4096
    ds_read_b128 v[108:111], v225 offset:4096
    s_waitcnt lgkmcnt(12)
    v_lshlrev_b32 v230, 16, v80
    v_and_b32 v231, 0xffff0000, v80
    v_pk_mul_f32 v[230:231], v[230:231], s[48:49]
    v_cvt_pk_bf16_f32 v80, v230, v231
    v_lshlrev_b32 v232, 16, v81
    v_and_b32 v233, 0xffff0000, v81
    v_pk_mul_f32 v[232:233], v[232:233], s[48:49]
    v_cvt_pk_bf16_f32 v81, v232, v233
    v_lshlrev_b32 v234, 16, v82
    v_and_b32 v235, 0xffff0000, v82
    v_pk_mul_f32 v[234:235], v[234:235], s[48:49]
    v_cvt_pk_bf16_f32 v82, v234, v235
    v_lshlrev_b32 v236, 16, v83
    v_and_b32 v237, 0xffff0000, v83
    v_pk_mul_f32 v[236:237], v[236:237], s[48:49]
    v_cvt_pk_bf16_f32 v83, v236, v237
    v_lshlrev_b32 v230, 16, v84
    v_and_b32 v231, 0xffff0000, v84
    v_pk_mul_f32 v[230:231], v[230:231], s[48:49]
    v_cvt_pk_bf16_f32 v84, v230, v231
    v_lshlrev_b32 v232, 16, v85
    v_and_b32 v233, 0xffff0000, v85
    v_pk_mul_f32 v[232:233], v[232:233], s[48:49]
    v_cvt_pk_bf16_f32 v85, v232, v233
    v_lshlrev_b32 v234, 16, v86
    v_and_b32 v235, 0xffff0000, v86
    v_pk_mul_f32 v[234:235], v[234:235], s[48:49]
    v_cvt_pk_bf16_f32 v86, v234, v235
    v_lshlrev_b32 v236, 16, v87
    v_and_b32 v237, 0xffff0000, v87
    v_pk_mul_f32 v[236:237], v[236:237], s[48:49]
    v_cvt_pk_bf16_f32 v87, v236, v237
    v_lshlrev_b32 v230, 16, v88
    v_and_b32 v231, 0xffff0000, v88
    v_pk_mul_f32 v[230:231], v[230:231], s[48:49]
    v_cvt_pk_bf16_f32 v88, v230, v231
    v_lshlrev_b32 v232, 16, v89
    v_and_b32 v233, 0xffff0000, v89
    v_pk_mul_f32 v[232:233], v[232:233], s[48:49]
    v_cvt_pk_bf16_f32 v89, v232, v233
    v_lshlrev_b32 v234, 16, v90
    v_and_b32 v235, 0xffff0000, v90
    v_pk_mul_f32 v[234:235], v[234:235], s[48:49]
    v_cvt_pk_bf16_f32 v90, v234, v235
    v_lshlrev_b32 v236, 16, v91
    v_and_b32 v237, 0xffff0000, v91
    v_pk_mul_f32 v[236:237], v[236:237], s[48:49]
    v_cvt_pk_bf16_f32 v91, v236, v237
    v_lshlrev_b32 v230, 16, v92
    v_and_b32 v231, 0xffff0000, v92
    v_pk_mul_f32 v[230:231], v[230:231], s[48:49]
    v_cvt_pk_bf16_f32 v92, v230, v231
    v_lshlrev_b32 v232, 16, v93
    v_and_b32 v233, 0xffff0000, v93
    v_pk_mul_f32 v[232:233], v[232:233], s[48:49]
    v_cvt_pk_bf16_f32 v93, v232, v233
    v_lshlrev_b32 v234, 16, v94
    v_and_b32 v235, 0xffff0000, v94
    v_pk_mul_f32 v[234:235], v[234:235], s[48:49]
    v_cvt_pk_bf16_f32 v94, v234, v235
    v_lshlrev_b32 v236, 16, v95
    v_and_b32 v237, 0xffff0000, v95
    v_pk_mul_f32 v[236:237], v[236:237], s[48:49]
    v_cvt_pk_bf16_f32 v95, v236, v237
    v_mfma_f32_16x16x32_bf16 v[218:221], a[132:135], v[80:83], 0
    v_mfma_f32_16x16x32_bf16 v[218:221], a[136:139], v[84:87], v[218:221]
    v_mfma_f32_16x16x32_bf16 v[218:221], a[140:143], v[88:91], v[218:221]
    v_mfma_f32_16x16x32_bf16 v[218:221], a[144:147], v[92:95], v[218:221]
    s_waitcnt vmcnt(8)
    s_barrier
    ds_read_b128 v[112:115], v222 offset:8192
    ds_read_b128 v[116:119], v223 offset:8192
    ds_read_b128 v[120:123], v224 offset:8192
    ds_read_b128 v[124:127], v225 offset:8192
    s_add_u32 s28, s28, 16384
    s_mov_b32 m0, s33
    s_nop 0
    buffer_load_dwordx4 v216, s[12:15], s28 offen offset:0 nt lds
    buffer_load_dwordx4 v217, s[12:15], s28 offen offset:1024 nt lds
    buffer_load_dwordx4 v216, s[12:15], s28 offen offset:2048 nt lds
    buffer_load_dwordx4 v217, s[12:15], s28 offen offset:3072 nt lds
    s_waitcnt lgkmcnt(4)
    v_lshlrev_b32 v230, 16, v96
    v_and_b32 v231, 0xffff0000, v96
    v_pk_mul_f32 v[230:231], v[230:231], s[48:49]
    v_cvt_pk_bf16_f32 v96, v230, v231
    v_lshlrev_b32 v232, 16, v97
    v_and_b32 v233, 0xffff0000, v97
    v_pk_mul_f32 v[232:233], v[232:233], s[48:49]
    v_cvt_pk_bf16_f32 v97, v232, v233
    v_lshlrev_b32 v234, 16, v98
    v_and_b32 v235, 0xffff0000, v98
    v_pk_mul_f32 v[234:235], v[234:235], s[48:49]
    v_cvt_pk_bf16_f32 v98, v234, v235
    v_lshlrev_b32 v236, 16, v99
    v_and_b32 v237, 0xffff0000, v99
    v_pk_mul_f32 v[236:237], v[236:237], s[48:49]
    v_cvt_pk_bf16_f32 v99, v236, v237
    v_lshlrev_b32 v230, 16, v100
    v_and_b32 v231, 0xffff0000, v100
    v_pk_mul_f32 v[230:231], v[230:231], s[48:49]
    v_cvt_pk_bf16_f32 v100, v230, v231
    v_lshlrev_b32 v232, 16, v101
    v_and_b32 v233, 0xffff0000, v101
    v_pk_mul_f32 v[232:233], v[232:233], s[48:49]
    v_cvt_pk_bf16_f32 v101, v232, v233
    v_lshlrev_b32 v234, 16, v102
    v_and_b32 v235, 0xffff0000, v102
    v_pk_mul_f32 v[234:235], v[234:235], s[48:49]
    v_cvt_pk_bf16_f32 v102, v234, v235
    v_lshlrev_b32 v236, 16, v103
    v_and_b32 v237, 0xffff0000, v103
    v_pk_mul_f32 v[236:237], v[236:237], s[48:49]
    v_cvt_pk_bf16_f32 v103, v236, v237
    v_lshlrev_b32 v230, 16, v104
    v_and_b32 v231, 0xffff0000, v104
    v_pk_mul_f32 v[230:231], v[230:231], s[48:49]
    v_cvt_pk_bf16_f32 v104, v230, v231
    v_lshlrev_b32 v232, 16, v105
    v_and_b32 v233, 0xffff0000, v105
    v_pk_mul_f32 v[232:233], v[232:233], s[48:49]
    v_cvt_pk_bf16_f32 v105, v232, v233
    v_lshlrev_b32 v234, 16, v106
    v_and_b32 v235, 0xffff0000, v106
    v_pk_mul_f32 v[234:235], v[234:235], s[48:49]
    v_cvt_pk_bf16_f32 v106, v234, v235
    v_lshlrev_b32 v236, 16, v107
    v_and_b32 v237, 0xffff0000, v107
    v_pk_mul_f32 v[236:237], v[236:237], s[48:49]
    v_cvt_pk_bf16_f32 v107, v236, v237
    v_lshlrev_b32 v230, 16, v108
    v_and_b32 v231, 0xffff0000, v108
    v_pk_mul_f32 v[230:231], v[230:231], s[48:49]
    v_cvt_pk_bf16_f32 v108, v230, v231
    v_lshlrev_b32 v232, 16, v109
    v_and_b32 v233, 0xffff0000, v109
    v_pk_mul_f32 v[232:233], v[232:233], s[48:49]
    v_cvt_pk_bf16_f32 v109, v232, v233
    v_lshlrev_b32 v234, 16, v110
    v_and_b32 v235, 0xffff0000, v110
    v_pk_mul_f32 v[234:235], v[234:235], s[48:49]
    v_cvt_pk_bf16_f32 v110, v234, v235
    v_lshlrev_b32 v236, 16, v111
    v_and_b32 v237, 0xffff0000, v111
    v_pk_mul_f32 v[236:237], v[236:237], s[48:49]
    v_cvt_pk_bf16_f32 v111, v236, v237
    v_mfma_f32_16x16x32_bf16 v[226:229], a[132:135], v[96:99], 0
    v_mfma_f32_16x16x32_bf16 v[226:229], a[136:139], v[100:103], v[226:229]
    v_mfma_f32_16x16x32_bf16 v[226:229], a[140:143], v[104:107], v[226:229]
    v_mfma_f32_16x16x32_bf16 v[226:229], a[144:147], v[108:111], v[226:229]
    v_max3_f32 v238, v218, v219, v220
    v_max_f32 v238, v238, v221
    v_mov_b32 v239, v238
    s_nop 1
    v_permlane16_swap_b32 v238, v239
    v_max_f32 v238, v238, v239
    v_mov_b32 v239, v238
    s_nop 1
    v_permlane32_swap_b32 v238, v239
    v_max_f32 v238, v238, v239
    v_sub_f32 v160, 0, v238
    v_sub_f32 v161, 0, v238
    v_sub_f32 v162, 0, v238
    v_sub_f32 v163, 0, v238
    s_waitcnt vmcnt(10)
    s_barrier
    ds_read_b128 v[128:131], v222 offset:12288
    ds_read_b128 v[132:135], v223 offset:12288
    ds_read_b128 v[136:139], v224 offset:12288
    ds_read_b128 v[140:143], v225 offset:12288
    s_waitcnt lgkmcnt(4)
    v_lshlrev_b32 v230, 16, v112
    v_and_b32 v231, 0xffff0000, v112
    v_pk_mul_f32 v[230:231], v[230:231], s[48:49]
    v_cvt_pk_bf16_f32 v112, v230, v231
    v_lshlrev_b32 v232, 16, v113
    v_and_b32 v233, 0xffff0000, v113
    v_pk_mul_f32 v[232:233], v[232:233], s[48:49]
    v_cvt_pk_bf16_f32 v113, v232, v233
    v_lshlrev_b32 v234, 16, v114
    v_and_b32 v235, 0xffff0000, v114
    v_pk_mul_f32 v[234:235], v[234:235], s[48:49]
    v_cvt_pk_bf16_f32 v114, v234, v235
    v_lshlrev_b32 v236, 16, v115
    v_and_b32 v237, 0xffff0000, v115
    v_pk_mul_f32 v[236:237], v[236:237], s[48:49]
    v_cvt_pk_bf16_f32 v115, v236, v237
    v_lshlrev_b32 v230, 16, v116
    v_and_b32 v231, 0xffff0000, v116
    v_pk_mul_f32 v[230:231], v[230:231], s[48:49]
    v_cvt_pk_bf16_f32 v116, v230, v231
    v_lshlrev_b32 v232, 16, v117
    v_and_b32 v233, 0xffff0000, v117
    v_pk_mul_f32 v[232:233], v[232:233], s[48:49]
    v_cvt_pk_bf16_f32 v117, v232, v233
    v_lshlrev_b32 v234, 16, v118
    v_and_b32 v235, 0xffff0000, v118
    v_pk_mul_f32 v[234:235], v[234:235], s[48:49]
    v_cvt_pk_bf16_f32 v118, v234, v235
    v_lshlrev_b32 v236, 16, v119
    v_and_b32 v237, 0xffff0000, v119
    v_pk_mul_f32 v[236:237], v[236:237], s[48:49]
    v_cvt_pk_bf16_f32 v119, v236, v237
    v_lshlrev_b32 v230, 16, v120
    v_and_b32 v231, 0xffff0000, v120
    v_pk_mul_f32 v[230:231], v[230:231], s[48:49]
    v_cvt_pk_bf16_f32 v120, v230, v231
    v_lshlrev_b32 v232, 16, v121
    v_and_b32 v233, 0xffff0000, v121
    v_pk_mul_f32 v[232:233], v[232:233], s[48:49]
    v_cvt_pk_bf16_f32 v121, v232, v233
    v_lshlrev_b32 v234, 16, v122
    v_and_b32 v235, 0xffff0000, v122
    v_pk_mul_f32 v[234:235], v[234:235], s[48:49]
    v_cvt_pk_bf16_f32 v122, v234, v235
    v_lshlrev_b32 v236, 16, v123
    v_and_b32 v237, 0xffff0000, v123
    v_pk_mul_f32 v[236:237], v[236:237], s[48:49]
    v_cvt_pk_bf16_f32 v123, v236, v237
    v_lshlrev_b32 v230, 16, v124
    v_and_b32 v231, 0xffff0000, v124
    v_pk_mul_f32 v[230:231], v[230:231], s[48:49]
    v_cvt_pk_bf16_f32 v124, v230, v231
    v_lshlrev_b32 v232, 16, v125
    v_and_b32 v233, 0xffff0000, v125
    v_pk_mul_f32 v[232:233], v[232:233], s[48:49]
    v_cvt_pk_bf16_f32 v125, v232, v233
    v_lshlrev_b32 v234, 16, v126
    v_and_b32 v235, 0xffff0000, v126
    v_pk_mul_f32 v[234:235], v[234:235], s[48:49]
    v_cvt_pk_bf16_f32 v126, v234, v235
    v_lshlrev_b32 v236, 16, v127
    v_and_b32 v237, 0xffff0000, v127
    v_pk_mul_f32 v[236:237], v[236:237], s[48:49]
    v_cvt_pk_bf16_f32 v127, v236, v237
    v_mfma_f32_16x16x32_bf16 v[218:221], a[132:135], v[112:115], 0
    v_mfma_f32_16x16x32_bf16 v[218:221], a[136:139], v[116:119], v[218:221]
    v_mfma_f32_16x16x32_bf16 v[218:221], a[140:143], v[120:123], v[218:221]
    v_mfma_f32_16x16x32_bf16 v[218:221], a[144:147], v[124:127], v[218:221]
    v_max3_f32 v238, v226, v227, v228
    v_max_f32 v238, v238, v229
    v_mov_b32 v239, v238
    s_nop 1
    v_permlane16_swap_b32 v238, v239
    v_max_f32 v238, v238, v239
    v_mov_b32 v239, v238
    s_nop 1
    v_permlane32_swap_b32 v238, v239
    v_max_f32 v238, v238, v239
    v_sub_f32 v164, 0, v238
    v_sub_f32 v165, 0, v238
    v_sub_f32 v166, 0, v238
    v_sub_f32 v167, 0, v238
    s_waitcnt lgkmcnt(4)
    v_mfma_f32_16x16x32_bf16 v[180:183], a[100:103], v[80:83], v[160:163]
    v_mfma_f32_16x16x32_bf16 v[180:183], a[104:107], v[84:87], v[180:183]
    v_mfma_f32_16x16x32_bf16 v[180:183], a[108:111], v[88:91], v[180:183]
    v_mfma_f32_16x16x32_bf16 v[180:183], a[112:115], v[92:95], v[180:183]
    v_mfma_f32_16x16x32_bf16 v[184:187], a[116:119], v[80:83], v[160:163]
    v_mfma_f32_16x16x32_bf16 v[184:187], a[120:123], v[84:87], v[184:187]
    v_mfma_f32_16x16x32_bf16 v[184:187], a[124:127], v[88:91], v[184:187]
    v_mfma_f32_16x16x32_bf16 v[184:187], a[128:131], v[92:95], v[184:187]
    s_waitcnt lgkmcnt(0)
    v_lshlrev_b32 v230, 16, v128
    v_and_b32 v231, 0xffff0000, v128
    v_pk_mul_f32 v[230:231], v[230:231], s[48:49]
    v_cvt_pk_bf16_f32 v128, v230, v231
    v_lshlrev_b32 v232, 16, v129
    v_and_b32 v233, 0xffff0000, v129
    v_pk_mul_f32 v[232:233], v[232:233], s[48:49]
    v_cvt_pk_bf16_f32 v129, v232, v233
    v_lshlrev_b32 v234, 16, v130
    v_and_b32 v235, 0xffff0000, v130
    v_pk_mul_f32 v[234:235], v[234:235], s[48:49]
    v_cvt_pk_bf16_f32 v130, v234, v235
    v_lshlrev_b32 v236, 16, v131
    v_and_b32 v237, 0xffff0000, v131
    v_pk_mul_f32 v[236:237], v[236:237], s[48:49]
    v_cvt_pk_bf16_f32 v131, v236, v237
    v_lshlrev_b32 v230, 16, v132
    v_and_b32 v231, 0xffff0000, v132
    v_pk_mul_f32 v[230:231], v[230:231], s[48:49]
    v_cvt_pk_bf16_f32 v132, v230, v231
    v_lshlrev_b32 v232, 16, v133
    v_and_b32 v233, 0xffff0000, v133
    v_pk_mul_f32 v[232:233], v[232:233], s[48:49]
    v_cvt_pk_bf16_f32 v133, v232, v233
    v_lshlrev_b32 v234, 16, v134
    v_and_b32 v235, 0xffff0000, v134
    v_pk_mul_f32 v[234:235], v[234:235], s[48:49]
    v_cvt_pk_bf16_f32 v134, v234, v235
    v_lshlrev_b32 v236, 16, v135
    v_and_b32 v237, 0xffff0000, v135
    v_pk_mul_f32 v[236:237], v[236:237], s[48:49]
    v_cvt_pk_bf16_f32 v135, v236, v237
    v_lshlrev_b32 v230, 16, v136
    v_and_b32 v231, 0xffff0000, v136
    v_pk_mul_f32 v[230:231], v[230:231], s[48:49]
    v_cvt_pk_bf16_f32 v136, v230, v231
    v_lshlrev_b32 v232, 16, v137
    v_and_b32 v233, 0xffff0000, v137
    v_pk_mul_f32 v[232:233], v[232:233], s[48:49]
    v_cvt_pk_bf16_f32 v137, v232, v233
    v_lshlrev_b32 v234, 16, v138
    v_and_b32 v235, 0xffff0000, v138
    v_pk_mul_f32 v[234:235], v[234:235], s[48:49]
    v_cvt_pk_bf16_f32 v138, v234, v235
    v_lshlrev_b32 v236, 16, v139
    v_and_b32 v237, 0xffff0000, v139
    v_pk_mul_f32 v[236:237], v[236:237], s[48:49]
    v_cvt_pk_bf16_f32 v139, v236, v237
    v_lshlrev_b32 v230, 16, v140
    v_and_b32 v231, 0xffff0000, v140
    v_pk_mul_f32 v[230:231], v[230:231], s[48:49]
    v_cvt_pk_bf16_f32 v140, v230, v231
    v_lshlrev_b32 v232, 16, v141
    v_and_b32 v233, 0xffff0000, v141
    v_pk_mul_f32 v[232:233], v[232:233], s[48:49]
    v_cvt_pk_bf16_f32 v141, v232, v233
    v_lshlrev_b32 v234, 16, v142
    v_and_b32 v235, 0xffff0000, v142
    v_pk_mul_f32 v[234:235], v[234:235], s[48:49]
    v_cvt_pk_bf16_f32 v142, v234, v235
    v_lshlrev_b32 v236, 16, v143
    v_and_b32 v237, 0xffff0000, v143
    v_pk_mul_f32 v[236:237], v[236:237], s[48:49]
    v_cvt_pk_bf16_f32 v143, v236, v237
    v_mfma_f32_16x16x32_bf16 v[226:229], a[132:135], v[128:131], 0
    v_mfma_f32_16x16x32_bf16 v[226:229], a[136:139], v[132:135], v[226:229]
    v_mfma_f32_16x16x32_bf16 v[226:229], a[140:143], v[136:139], v[226:229]
    v_mfma_f32_16x16x32_bf16 v[226:229], a[144:147], v[140:143], v[226:229]
    v_max3_f32 v238, v218, v219, v220
    v_max_f32 v238, v238, v221
    v_mov_b32 v239, v238
    s_nop 1
    v_permlane16_swap_b32 v238, v239
    v_max_f32 v238, v238, v239
    v_mov_b32 v239, v238
    s_nop 1
    v_permlane32_swap_b32 v238, v239
    v_max_f32 v238, v238, v239
    v_sub_f32 v168, 0, v238
    v_sub_f32 v169, 0, v238
    v_sub_f32 v170, 0, v238
    v_sub_f32 v171, 0, v238
    v_mfma_f32_16x16x32_bf16 v[188:191], a[100:103], v[96:99], v[164:167]
    v_exp_f32 v180, v180
    v_mfma_f32_16x16x32_bf16 v[188:191], a[104:107], v[100:103], v[188:191]
    v_exp_f32 v181, v181
    v_mfma_f32_16x16x32_bf16 v[188:191], a[108:111], v[104:107], v[188:191]
    v_exp_f32 v182, v182
    v_mfma_f32_16x16x32_bf16 v[188:191], a[112:115], v[108:111], v[188:191]
    v_exp_f32 v183, v183
    v_mfma_f32_16x16x32_bf16 v[192:195], a[116:119], v[96:99], v[164:167]
    v_exp_f32 v184, v184
    v_mfma_f32_16x16x32_bf16 v[192:195], a[120:123], v[100:103], v[192:195]
    v_exp_f32 v185, v185
    v_mfma_f32_16x16x32_bf16 v[192:195], a[124:127], v[104:107], v[192:195]
    v_exp_f32 v186, v186
    v_mfma_f32_16x16x32_bf16 v[192:195], a[128:131], v[108:111], v[192:195]
    v_exp_f32 v187, v187
    s_nop 0
    v_cvt_pk_bf16_f32 v196, v180, v181
    v_cvt_pk_bf16_f32 v197, v182, v183
    v_cvt_pk_bf16_f32 v198, v184, v185
    v_cvt_pk_bf16_f32 v199, v186, v187
    s_waitcnt vmcnt(8)
    s_barrier
    ds_read_b128 v[144:147], v222 offset:16384
    ds_read_b128 v[148:151], v223 offset:16384
    ds_read_b128 v[152:155], v224 offset:16384
    ds_read_b128 v[156:159], v225 offset:16384
    s_mov_b32 m0, s37
    s_nop 0
    buffer_load_dwordx4 v216, s[16:19], s28 offen offset:0 nt lds
    buffer_load_dwordx4 v217, s[16:19], s28 offen offset:1024 nt lds
    buffer_load_dwordx4 v216, s[16:19], s28 offen offset:2048 nt lds
    buffer_load_dwordx4 v217, s[16:19], s28 offen offset:3072 nt lds
    s_waitcnt lgkmcnt(0)
    v_lshlrev_b32 v230, 16, v144
    v_and_b32 v231, 0xffff0000, v144
    v_pk_mul_f32 v[230:231], v[230:231], s[48:49]
    v_cvt_pk_bf16_f32 v144, v230, v231
    v_lshlrev_b32 v232, 16, v145
    v_and_b32 v233, 0xffff0000, v145
    v_pk_mul_f32 v[232:233], v[232:233], s[48:49]
    v_cvt_pk_bf16_f32 v145, v232, v233
    v_lshlrev_b32 v234, 16, v146
    v_and_b32 v235, 0xffff0000, v146
    v_pk_mul_f32 v[234:235], v[234:235], s[48:49]
    v_cvt_pk_bf16_f32 v146, v234, v235
    v_lshlrev_b32 v236, 16, v147
    v_and_b32 v237, 0xffff0000, v147
    v_pk_mul_f32 v[236:237], v[236:237], s[48:49]
    v_cvt_pk_bf16_f32 v147, v236, v237
    v_lshlrev_b32 v230, 16, v148
    v_and_b32 v231, 0xffff0000, v148
    v_pk_mul_f32 v[230:231], v[230:231], s[48:49]
    v_cvt_pk_bf16_f32 v148, v230, v231
    v_lshlrev_b32 v232, 16, v149
    v_and_b32 v233, 0xffff0000, v149
    v_pk_mul_f32 v[232:233], v[232:233], s[48:49]
    v_cvt_pk_bf16_f32 v149, v232, v233
    v_lshlrev_b32 v234, 16, v150
    v_and_b32 v235, 0xffff0000, v150
    v_pk_mul_f32 v[234:235], v[234:235], s[48:49]
    v_cvt_pk_bf16_f32 v150, v234, v235
    v_lshlrev_b32 v236, 16, v151
    v_and_b32 v237, 0xffff0000, v151
    v_pk_mul_f32 v[236:237], v[236:237], s[48:49]
    v_cvt_pk_bf16_f32 v151, v236, v237
    v_lshlrev_b32 v230, 16, v152
    v_and_b32 v231, 0xffff0000, v152
    v_pk_mul_f32 v[230:231], v[230:231], s[48:49]
    v_cvt_pk_bf16_f32 v152, v230, v231
    v_lshlrev_b32 v232, 16, v153
    v_and_b32 v233, 0xffff0000, v153
    v_pk_mul_f32 v[232:233], v[232:233], s[48:49]
    v_cvt_pk_bf16_f32 v153, v232, v233
    v_lshlrev_b32 v234, 16, v154
    v_and_b32 v235, 0xffff0000, v154
    v_pk_mul_f32 v[234:235], v[234:235], s[48:49]
    v_cvt_pk_bf16_f32 v154, v234, v235
    v_lshlrev_b32 v236, 16, v155
    v_and_b32 v237, 0xffff0000, v155
    v_pk_mul_f32 v[236:237], v[236:237], s[48:49]
    v_cvt_pk_bf16_f32 v155, v236, v237
    v_lshlrev_b32 v230, 16, v156
    v_and_b32 v231, 0xffff0000, v156
    v_pk_mul_f32 v[230:231], v[230:231], s[48:49]
    v_cvt_pk_bf16_f32 v156, v230, v231
    v_lshlrev_b32 v232, 16, v157
    v_and_b32 v233, 0xffff0000, v157
    v_pk_mul_f32 v[232:233], v[232:233], s[48:49]
    v_cvt_pk_bf16_f32 v157, v232, v233
    v_lshlrev_b32 v234, 16, v158
    v_and_b32 v235, 0xffff0000, v158
    v_pk_mul_f32 v[234:235], v[234:235], s[48:49]
    v_cvt_pk_bf16_f32 v158, v234, v235
    v_lshlrev_b32 v236, 16, v159
    v_and_b32 v237, 0xffff0000, v159
    v_pk_mul_f32 v[236:237], v[236:237], s[48:49]
    v_cvt_pk_bf16_f32 v159, v236, v237
    v_mfma_f32_16x16x32_bf16 v[218:221], a[132:135], v[144:147], 0
    v_mfma_f32_16x16x32_bf16 v[218:221], a[136:139], v[148:151], v[218:221]
    v_mfma_f32_16x16x32_bf16 v[218:221], a[140:143], v[152:155], v[218:221]
    v_mfma_f32_16x16x32_bf16 v[218:221], a[144:147], v[156:159], v[218:221]
    v_max3_f32 v238, v226, v227, v228
    v_max_f32 v238, v238, v229
    v_mov_b32 v239, v238
    s_nop 1
    v_permlane16_swap_b32 v238, v239
    v_max_f32 v238, v238, v239
    v_mov_b32 v239, v238
    s_nop 1
    v_permlane32_swap_b32 v238, v239
    v_max_f32 v238, v238, v239
    v_sub_f32 v172, 0, v238
    v_sub_f32 v173, 0, v238
    v_sub_f32 v174, 0, v238
    v_sub_f32 v175, 0, v238
    s_nop 3
    v_max3_f32 v238, v218, v219, v220
    v_max_f32 v238, v238, v221
    v_mov_b32 v239, v238
    s_nop 1
    v_permlane16_swap_b32 v238, v239
    v_max_f32 v238, v238, v239
    v_mov_b32 v239, v238
    s_nop 1
    v_permlane32_swap_b32 v238, v239
    v_max_f32 v238, v238, v239
    v_sub_f32 v176, 0, v238
    v_sub_f32 v177, 0, v238
    v_sub_f32 v178, 0, v238
    v_sub_f32 v179, 0, v238
    s_waitcnt vmcnt(8)
    s_barrier
    ds_read_b64_tr_b16 a[164:165], v208 offset:0
    ds_read_b64_tr_b16 a[166:167], v208 offset:4096
    ds_read_b64_tr_b16 a[168:169], v209 offset:0
    ds_read_b64_tr_b16 a[170:171], v209 offset:4096
    ds_read_b64_tr_b16 a[172:173], v210 offset:0
    ds_read_b64_tr_b16 a[174:175], v210 offset:4096
    ds_read_b64_tr_b16 a[176:177], v211 offset:0
    ds_read_b64_tr_b16 a[178:179], v211 offset:4096
    ds_read_b64_tr_b16 a[180:181], v212 offset:0
    ds_read_b64_tr_b16 a[182:183], v212 offset:4096
    ds_read_b64_tr_b16 a[184:185], v213 offset:0
    ds_read_b64_tr_b16 a[186:187], v213 offset:4096
    ds_read_b64_tr_b16 a[188:189], v214 offset:0
    ds_read_b64_tr_b16 a[190:191], v214 offset:4096
    ds_read_b64_tr_b16 a[192:193], v215 offset:0
    ds_read_b64_tr_b16 a[194:195], v215 offset:4096
    s_add_u32 s28, s28, 16384
    s_mov_b32 m0, s34
    s_nop 0
    buffer_load_dwordx4 v216, s[12:15], s28 offen offset:0 nt lds
    buffer_load_dwordx4 v217, s[12:15], s28 offen offset:1024 nt lds
    buffer_load_dwordx4 v216, s[12:15], s28 offen offset:2048 nt lds
    buffer_load_dwordx4 v217, s[12:15], s28 offen offset:3072 nt lds
    s_mov_b32 m0, s38
    v_mfma_f32_16x16x32_bf16 v[180:183], a[100:103], v[112:115], v[168:171]
    v_exp_f32 v188, v188
    v_mfma_f32_16x16x32_bf16 v[180:183], a[104:107], v[116:119], v[180:183]
    v_exp_f32 v189, v189
    v_mfma_f32_16x16x32_bf16 v[180:183], a[108:111], v[120:123], v[180:183]
    v_cvt_pk_bf16_f32 v200, v188, v189
    v_mfma_f32_16x16x32_bf16 v[180:183], a[112:115], v[124:127], v[180:183]
    buffer_load_dwordx4 v216, s[16:19], s28 offen offset:0 nt lds
    v_mfma_f32_16x16x32_bf16 v[184:187], a[116:119], v[112:115], v[168:171]
    v_exp_f32 v190, v190
    v_mfma_f32_16x16x32_bf16 v[184:187], a[120:123], v[116:119], v[184:187]
    v_exp_f32 v191, v191
    v_mfma_f32_16x16x32_bf16 v[184:187], a[124:127], v[120:123], v[184:187]
    v_cvt_pk_bf16_f32 v201, v190, v191
    v_mfma_f32_16x16x32_bf16 v[184:187], a[128:131], v[124:127], v[184:187]
    s_waitcnt lgkmcnt(0)
    buffer_load_dwordx4 v217, s[16:19], s28 offen offset:1024 nt lds
    v_mfma_f32_16x16x32_bf16 v[0:3], a[164:167], v[196:199], v[0:3]
    v_exp_f32 v192, v192
    v_mfma_f32_16x16x32_bf16 v[4:7], a[168:171], v[196:199], v[4:7]
    v_exp_f32 v193, v193
    v_mfma_f32_16x16x32_bf16 v[8:11], a[172:175], v[196:199], v[8:11]
    v_cvt_pk_bf16_f32 v202, v192, v193
    v_mfma_f32_16x16x32_bf16 v[12:15], a[176:179], v[196:199], v[12:15]
    buffer_load_dwordx4 v216, s[16:19], s28 offen offset:2048 nt lds
    v_mfma_f32_16x16x32_bf16 a[0:3], a[180:183], v[196:199], a[0:3]
    v_exp_f32 v194, v194
    v_mfma_f32_16x16x32_bf16 a[4:7], a[184:187], v[196:199], a[4:7]
    v_exp_f32 v195, v195
    v_mfma_f32_16x16x32_bf16 a[8:11], a[188:191], v[196:199], a[8:11]
    v_cvt_pk_bf16_f32 v203, v194, v195
    v_mfma_f32_16x16x32_bf16 a[12:15], a[192:195], v[196:199], a[12:15]
    buffer_load_dwordx4 v217, s[16:19], s28 offen offset:3072 nt lds
    v_mfma_f32_16x16x32_bf16 a[80:83], a[228:231], v[196:199], a[80:83]
    s_waitcnt vmcnt(8)
    s_mov_b32 s45, 8
    s_branch L_entry
.p2align 6
L_loop:
    v_mfma_f32_16x16x32_bf16 v[188:191], a[100:103], v[96:99], v[164:167]
    v_exp_f32 v180, v180
    v_mfma_f32_16x16x32_bf16 v[188:191], a[104:107], v[100:103], v[188:191]
    v_exp_f32 v181, v181
    v_mfma_f32_16x16x32_bf16 v[188:191], a[108:111], v[104:107], v[188:191]
    ds_read_b64_tr_b16 a[186:187], v213 offset:4096
    v_cvt_pk_bf16_f32 v196, v180, v181
    v_mfma_f32_16x16x32_bf16 v[188:191], a[112:115], v[108:111], v[188:191]
    ds_read_b64_tr_b16 a[188:189], v214 offset:0
    v_mfma_f32_16x16x32_bf16 v[192:195], a[116:119], v[96:99], v[164:167]
    v_exp_f32 v182, v182
    v_mfma_f32_16x16x32_bf16 v[192:195], a[120:123], v[100:103], v[192:195]
    s_mov_b32 m0, s38
    v_exp_f32 v183, v183
    v_mfma_f32_16x16x32_bf16 v[192:195], a[124:127], v[104:107], v[192:195]
    ds_read_b64_tr_b16 a[190:191], v214 offset:4096
    v_cvt_pk_bf16_f32 v197, v182, v183
    v_mfma_f32_16x16x32_bf16 v[192:195], a[128:131], v[108:111], v[192:195]
    buffer_load_dwordx4 v216, s[16:19], s28 offen offset:0 nt lds
    v_mfma_f32_16x16x32_bf16 v[64:67], a[196:199], v[200:203], v[64:67]
    v_exp_f32 v184, v184
    v_mfma_f32_16x16x32_bf16 v[68:71], a[200:203], v[200:203], v[68:71]
    v_exp_f32 v185, v185
    v_mfma_f32_16x16x32_bf16 v[72:75], a[204:207], v[200:203], v[72:75]
    ds_read_b64_tr_b16 a[192:193], v215 offset:0
    v_cvt_pk_bf16_f32 v198, v184, v185
    v_mfma_f32_16x16x32_bf16 v[76:79], a[208:211], v[200:203], v[76:79]
    v_mfma_f32_16x16x32_bf16 a[64:67], a[212:215], v[200:203], a[64:67]
    v_exp_f32 v186, v186
    v_mfma_f32_16x16x32_bf16 a[68:71], a[216:219], v[200:203], a[68:71]
    v_exp_f32 v187, v187
    v_mfma_f32_16x16x32_bf16 a[72:75], a[220:223], v[200:203], a[72:75]
    ds_read_b64_tr_b16 a[194:195], v215 offset:4096
    v_cvt_pk_bf16_f32 v199, v186, v187
    v_mfma_f32_16x16x32_bf16 a[76:79], a[224:227], v[200:203], a[76:79]
    buffer_load_dwordx4 v217, s[16:19], s28 offen offset:1024 nt lds
    v_mfma_f32_16x16x32_bf16 v[180:183], a[100:103], v[112:115], v[168:171]
    v_exp_f32 v188, v188
    v_mfma_f32_16x16x32_bf16 v[180:183], a[104:107], v[116:119], v[180:183]
    v_exp_f32 v189, v189
    v_mfma_f32_16x16x32_bf16 v[180:183], a[108:111], v[120:123], v[180:183]
    v_cvt_pk_bf16_f32 v200, v188, v189
    v_mfma_f32_16x16x32_bf16 v[180:183], a[112:115], v[124:127], v[180:183]
    v_mfma_f32_16x16x32_bf16 v[184:187], a[116:119], v[112:115], v[168:171]
    v_exp_f32 v190, v190
    v_mfma_f32_16x16x32_bf16 v[184:187], a[120:123], v[116:119], v[184:187]
    v_exp_f32 v191, v191
    v_mfma_f32_16x16x32_bf16 v[184:187], a[124:127], v[120:123], v[184:187]
    v_cvt_pk_bf16_f32 v201, v190, v191
    v_mfma_f32_16x16x32_bf16 v[184:187], a[128:131], v[124:127], v[184:187]
    s_waitcnt lgkmcnt(0)
    buffer_load_dwordx4 v216, s[16:19], s28 offen offset:2048 nt lds
    v_mfma_f32_16x16x32_bf16 v[0:3], a[164:167], v[196:199], v[0:3]
    v_exp_f32 v192, v192
    v_mfma_f32_16x16x32_bf16 v[4:7], a[168:171], v[196:199], v[4:7]
    v_exp_f32 v193, v193
    v_mfma_f32_16x16x32_bf16 v[8:11], a[172:175], v[196:199], v[8:11]
    v_cvt_pk_bf16_f32 v202, v192, v193
    v_mfma_f32_16x16x32_bf16 v[12:15], a[176:179], v[196:199], v[12:15]
    v_mfma_f32_16x16x32_bf16 a[0:3], a[180:183], v[196:199], a[0:3]
    v_exp_f32 v194, v194
    v_mfma_f32_16x16x32_bf16 a[4:7], a[184:187], v[196:199], a[4:7]
    v_exp_f32 v195, v195
    v_mfma_f32_16x16x32_bf16 a[8:11], a[188:191], v[196:199], a[8:11]
    v_cvt_pk_bf16_f32 v203, v194, v195
    v_mfma_f32_16x16x32_bf16 a[12:15], a[192:195], v[196:199], a[12:15]
    buffer_load_dwordx4 v217, s[16:19], s28 offen offset:3072 nt lds
    v_mfma_f32_16x16x32_bf16 a[80:83], a[228:231], v[196:199], a[80:83]
    s_waitcnt vmcnt(8)
L_entry:
    v_mfma_f32_16x16x32_bf16 v[188:191], a[100:103], v[128:131], v[172:175]
    s_barrier
    v_exp_f32 v180, v180
    v_mfma_f32_16x16x32_bf16 v[188:191], a[104:107], v[132:135], v[188:191]
    v_exp_f32 v181, v181
    v_mfma_f32_16x16x32_bf16 v[188:191], a[108:111], v[136:139], v[188:191]
    ds_read_b128 a[132:135], v204 offset:16384
    v_cvt_pk_bf16_f32 v196, v180, v181
    v_mfma_f32_16x16x32_bf16 v[188:191], a[112:115], v[140:143], v[188:191]
    ds_read_b128 a[136:139], v205 offset:16384
    v_mfma_f32_16x16x32_bf16 v[192:195], a[116:119], v[128:131], v[172:175]
    v_exp_f32 v182, v182
    v_mfma_f32_16x16x32_bf16 v[192:195], a[120:123], v[132:135], v[192:195]
    v_exp_f32 v183, v183
    v_mfma_f32_16x16x32_bf16 v[192:195], a[124:127], v[136:139], v[192:195]
    ds_read_b128 a[140:143], v206 offset:16384
    v_cvt_pk_bf16_f32 v197, v182, v183
    v_mfma_f32_16x16x32_bf16 v[192:195], a[128:131], v[140:143], v[192:195]
    ds_read_b128 a[144:147], v207 offset:16384
    v_mfma_f32_16x16x32_bf16 v[16:19], a[164:167], v[200:203], v[16:19]
    s_add_u32 s28, s28, 16384
    v_exp_f32 v184, v184
    v_mfma_f32_16x16x32_bf16 v[20:23], a[168:171], v[200:203], v[20:23]
    s_mov_b32 m0, s35
    v_exp_f32 v185, v185
    v_mfma_f32_16x16x32_bf16 v[24:27], a[172:175], v[200:203], v[24:27]
    ds_read_b128 a[148:151], v204 offset:20480
    v_cvt_pk_bf16_f32 v198, v184, v185
    v_mfma_f32_16x16x32_bf16 v[28:31], a[176:179], v[200:203], v[28:31]
    buffer_load_dwordx4 v216, s[12:15], s28 offen offset:0 nt lds
    v_mfma_f32_16x16x32_bf16 a[16:19], a[180:183], v[200:203], a[16:19]
    v_exp_f32 v186, v186
    v_mfma_f32_16x16x32_bf16 a[20:23], a[184:187], v[200:203], a[20:23]
    v_exp_f32 v187, v187
    v_mfma_f32_16x16x32_bf16 a[24:27], a[188:191], v[200:203], a[24:27]
    ds_read_b128 a[152:155], v205 offset:20480
    v_cvt_pk_bf16_f32 v199, v186, v187
    v_mfma_f32_16x16x32_bf16 a[28:31], a[192:195], v[200:203], a[28:31]
    ds_read_b128 a[156:159], v206 offset:20480
    v_mfma_f32_16x16x32_bf16 a[84:87], a[228:231], v[200:203], a[84:87]
    ds_read_b64_tr_b16 a[196:197], v208 offset:16384
    v_mfma_f32_16x16x32_bf16 v[180:183], a[100:103], v[144:147], v[176:179]
    v_exp_f32 v188, v188
    v_mfma_f32_16x16x32_bf16 v[180:183], a[104:107], v[148:151], v[180:183]
    v_exp_f32 v189, v189
    v_mfma_f32_16x16x32_bf16 v[180:183], a[108:111], v[152:155], v[180:183]
    ds_read_b128 a[160:163], v207 offset:20480
    v_cvt_pk_bf16_f32 v200, v188, v189
    v_mfma_f32_16x16x32_bf16 v[180:183], a[112:115], v[156:159], v[180:183]
    buffer_load_dwordx4 v217, s[12:15], s28 offen offset:1024 nt lds
    v_mfma_f32_16x16x32_bf16 v[184:187], a[116:119], v[144:147], v[176:179]
    v_exp_f32 v190, v190
    v_mfma_f32_16x16x32_bf16 v[184:187], a[120:123], v[148:151], v[184:187]
    v_exp_f32 v191, v191
    v_mfma_f32_16x16x32_bf16 v[184:187], a[124:127], v[152:155], v[184:187]
    ds_read_b64_tr_b16 a[198:199], v208 offset:20480
    v_cvt_pk_bf16_f32 v201, v190, v191
    v_mfma_f32_16x16x32_bf16 v[184:187], a[128:131], v[156:159], v[184:187]
    ds_read_b64_tr_b16 a[200:201], v209 offset:16384
    v_mfma_f32_16x16x32_bf16 v[32:35], a[164:167], v[196:199], v[32:35]
    v_exp_f32 v192, v192
    v_mfma_f32_16x16x32_bf16 v[36:39], a[168:171], v[196:199], v[36:39]
    v_exp_f32 v193, v193
    v_mfma_f32_16x16x32_bf16 v[40:43], a[172:175], v[196:199], v[40:43]
    ds_read_b64_tr_b16 a[202:203], v209 offset:20480
    v_cvt_pk_bf16_f32 v202, v192, v193
    v_mfma_f32_16x16x32_bf16 v[44:47], a[176:179], v[196:199], v[44:47]
    ds_read_b64_tr_b16 a[204:205], v210 offset:16384
    v_mfma_f32_16x16x32_bf16 a[32:35], a[180:183], v[196:199], a[32:35]
    v_exp_f32 v194, v194
    v_mfma_f32_16x16x32_bf16 a[36:39], a[184:187], v[196:199], a[36:39]
    v_exp_f32 v195, v195
    v_mfma_f32_16x16x32_bf16 a[40:43], a[188:191], v[196:199], a[40:43]
    ds_read_b64_tr_b16 a[206:207], v210 offset:20480
    v_cvt_pk_bf16_f32 v203, v194, v195
    v_mfma_f32_16x16x32_bf16 a[44:47], a[192:195], v[196:199], a[44:47]
    buffer_load_dwordx4 v216, s[12:15], s28 offen offset:2048 nt lds
    v_mfma_f32_16x16x32_bf16 a[88:91], a[228:231], v[196:199], a[88:91]
    s_waitcnt lgkmcnt(5)
    ds_read_b64_tr_b16 a[208:209], v211 offset:16384
    v_mfma_f32_16x16x32_bf16 v[188:191], a[132:135], v[80:83], v[160:163]
    v_exp_f32 v180, v180
    v_mfma_f32_16x16x32_bf16 v[188:191], a[136:139], v[84:87], v[188:191]
    v_exp_f32 v181, v181
    v_mfma_f32_16x16x32_bf16 v[188:191], a[140:143], v[88:91], v[188:191]
    ds_read_b64_tr_b16 a[210:211], v211 offset:20480
    v_cvt_pk_bf16_f32 v196, v180, v181
    v_mfma_f32_16x16x32_bf16 v[188:191], a[144:147], v[92:95], v[188:191]
    v_add_f32 v250, v250, v180
    v_add_f32 v251, v251, v181
    v_mfma_f32_16x16x32_bf16 v[192:195], a[148:151], v[80:83], v[160:163]
    v_exp_f32 v182, v182
    v_mfma_f32_16x16x32_bf16 v[192:195], a[152:155], v[84:87], v[192:195]
    v_exp_f32 v183, v183
    v_mfma_f32_16x16x32_bf16 v[192:195], a[156:159], v[88:91], v[192:195]
    ds_read_b64_tr_b16 a[212:213], v212 offset:16384
    v_cvt_pk_bf16_f32 v197, v182, v183
    v_mfma_f32_16x16x32_bf16 v[192:195], a[160:163], v[92:95], v[192:195]
    v_add_f32 v250, v250, v182
    v_add_f32 v251, v251, v183
    v_mfma_f32_16x16x32_bf16 v[48:51], a[164:167], v[200:203], v[48:51]
    v_exp_f32 v184, v184
    v_mfma_f32_16x16x32_bf16 v[52:55], a[168:171], v[200:203], v[52:55]
    v_exp_f32 v185, v185
    v_mfma_f32_16x16x32_bf16 v[56:59], a[172:175], v[200:203], v[56:59]
    ds_read_b64_tr_b16 a[214:215], v212 offset:20480
    v_cvt_pk_bf16_f32 v198, v184, v185
    v_mfma_f32_16x16x32_bf16 v[60:63], a[176:179], v[200:203], v[60:63]
    v_add_f32 v250, v250, v184
    v_add_f32 v251, v251, v185
    v_mfma_f32_16x16x32_bf16 a[48:51], a[180:183], v[200:203], a[48:51]
    v_exp_f32 v186, v186
    v_mfma_f32_16x16x32_bf16 a[52:55], a[184:187], v[200:203], a[52:55]
    v_exp_f32 v187, v187
    v_mfma_f32_16x16x32_bf16 a[56:59], a[188:191], v[200:203], a[56:59]
    ds_read_b64_tr_b16 a[216:217], v213 offset:16384
    v_cvt_pk_bf16_f32 v199, v186, v187
    v_mfma_f32_16x16x32_bf16 a[60:63], a[192:195], v[200:203], a[60:63]
    v_add_f32 v250, v250, v186
    v_add_f32 v251, v251, v187
    v_mfma_f32_16x16x32_bf16 a[92:95], a[228:231], v[200:203], a[92:95]
    buffer_load_dwordx4 v217, s[12:15], s28 offen offset:3072 nt lds
    v_mfma_f32_16x16x32_bf16 v[180:183], a[132:135], v[96:99], v[164:167]
    v_exp_f32 v188, v188
    v_mfma_f32_16x16x32_bf16 v[180:183], a[136:139], v[100:103], v[180:183]
    v_exp_f32 v189, v189
    v_mfma_f32_16x16x32_bf16 v[180:183], a[140:143], v[104:107], v[180:183]
    ds_read_b64_tr_b16 a[218:219], v213 offset:20480
    v_cvt_pk_bf16_f32 v200, v188, v189
    v_mfma_f32_16x16x32_bf16 v[180:183], a[144:147], v[108:111], v[180:183]
    ds_read_b64_tr_b16 a[220:221], v214 offset:16384
    v_mfma_f32_16x16x32_bf16 v[184:187], a[148:151], v[96:99], v[164:167]
    v_exp_f32 v190, v190
    v_mfma_f32_16x16x32_bf16 v[184:187], a[152:155], v[100:103], v[184:187]
    s_mov_b32 m0, s39
    v_exp_f32 v191, v191
    v_mfma_f32_16x16x32_bf16 v[184:187], a[156:159], v[104:107], v[184:187]
    ds_read_b64_tr_b16 a[222:223], v214 offset:20480
    v_cvt_pk_bf16_f32 v201, v190, v191
    v_mfma_f32_16x16x32_bf16 v[184:187], a[160:163], v[108:111], v[184:187]
    buffer_load_dwordx4 v216, s[16:19], s28 offen offset:0 nt lds
    v_mfma_f32_16x16x32_bf16 v[64:67], a[164:167], v[196:199], v[64:67]
    v_exp_f32 v192, v192
    v_mfma_f32_16x16x32_bf16 v[68:71], a[168:171], v[196:199], v[68:71]
    v_exp_f32 v193, v193
    v_mfma_f32_16x16x32_bf16 v[72:75], a[172:175], v[196:199], v[72:75]
    ds_read_b64_tr_b16 a[224:225], v215 offset:16384
    v_cvt_pk_bf16_f32 v202, v192, v193
    v_mfma_f32_16x16x32_bf16 v[76:79], a[176:179], v[196:199], v[76:79]
    v_mfma_f32_16x16x32_bf16 a[64:67], a[180:183], v[196:199], a[64:67]
    v_exp_f32 v194, v194
    v_mfma_f32_16x16x32_bf16 a[68:71], a[184:187], v[196:199], a[68:71]
    v_exp_f32 v195, v195
    v_mfma_f32_16x16x32_bf16 a[72:75], a[188:191], v[196:199], a[72:75]
    ds_read_b64_tr_b16 a[226:227], v215 offset:20480
    v_cvt_pk_bf16_f32 v203, v194, v195
    v_mfma_f32_16x16x32_bf16 a[76:79], a[192:195], v[196:199], a[76:79]
    buffer_load_dwordx4 v217, s[16:19], s28 offen offset:1024 nt lds
    v_mfma_f32_16x16x32_bf16 v[188:191], a[132:135], v[112:115], v[168:171]
    v_exp_f32 v180, v180
    v_mfma_f32_16x16x32_bf16 v[188:191], a[136:139], v[116:119], v[188:191]
    v_exp_f32 v181, v181
    v_mfma_f32_16x16x32_bf16 v[188:191], a[140:143], v[120:123], v[188:191]
    v_cvt_pk_bf16_f32 v196, v180, v181
    v_mfma_f32_16x16x32_bf16 v[188:191], a[144:147], v[124:127], v[188:191]
    v_mfma_f32_16x16x32_bf16 v[192:195], a[148:151], v[112:115], v[168:171]
    v_exp_f32 v182, v182
    v_mfma_f32_16x16x32_bf16 v[192:195], a[152:155], v[116:119], v[192:195]
    v_exp_f32 v183, v183
    v_mfma_f32_16x16x32_bf16 v[192:195], a[156:159], v[120:123], v[192:195]
    v_cvt_pk_bf16_f32 v197, v182, v183
    v_mfma_f32_16x16x32_bf16 v[192:195], a[160:163], v[124:127], v[192:195]
    s_waitcnt lgkmcnt(0)
    buffer_load_dwordx4 v216, s[16:19], s28 offen offset:2048 nt lds
    v_mfma_f32_16x16x32_bf16 v[0:3], a[196:199], v[200:203], v[0:3]
    v_exp_f32 v184, v184
    v_mfma_f32_16x16x32_bf16 v[4:7], a[200:203], v[200:203], v[4:7]
    v_exp_f32 v185, v185
    v_mfma_f32_16x16x32_bf16 v[8:11], a[204:207], v[200:203], v[8:11]
    v_cvt_pk_bf16_f32 v198, v184, v185
    v_mfma_f32_16x16x32_bf16 v[12:15], a[208:211], v[200:203], v[12:15]
    v_mfma_f32_16x16x32_bf16 a[0:3], a[212:215], v[200:203], a[0:3]
    v_exp_f32 v186, v186
    v_mfma_f32_16x16x32_bf16 a[4:7], a[216:219], v[200:203], a[4:7]
    v_exp_f32 v187, v187
    v_mfma_f32_16x16x32_bf16 a[8:11], a[220:223], v[200:203], a[8:11]
    v_cvt_pk_bf16_f32 v199, v186, v187
    v_mfma_f32_16x16x32_bf16 a[12:15], a[224:227], v[200:203], a[12:15]
    buffer_load_dwordx4 v217, s[16:19], s28 offen offset:3072 nt lds
    v_mfma_f32_16x16x32_bf16 a[80:83], a[228:231], v[200:203], a[80:83]
    s_waitcnt vmcnt(8)
    v_mfma_f32_16x16x32_bf16 v[180:183], a[132:135], v[128:131], v[172:175]
    s_barrier
    v_exp_f32 v188, v188
    v_mfma_f32_16x16x32_bf16 v[180:183], a[136:139], v[132:135], v[180:183]
    v_exp_f32 v189, v189
    v_mfma_f32_16x16x32_bf16 v[180:183], a[140:143], v[136:139], v[180:183]
    ds_read_b128 a[100:103], v204 offset:32768
    v_cvt_pk_bf16_f32 v200, v188, v189
    v_mfma_f32_16x16x32_bf16 v[180:183], a[144:147], v[140:143], v[180:183]
    ds_read_b128 a[104:107], v205 offset:32768
    v_mfma_f32_16x16x32_bf16 v[184:187], a[148:151], v[128:131], v[172:175]
    v_exp_f32 v190, v190
    v_mfma_f32_16x16x32_bf16 v[184:187], a[152:155], v[132:135], v[184:187]
    v_exp_f32 v191, v191
    v_mfma_f32_16x16x32_bf16 v[184:187], a[156:159], v[136:139], v[184:187]
    ds_read_b128 a[108:111], v206 offset:32768
    v_cvt_pk_bf16_f32 v201, v190, v191
    v_mfma_f32_16x16x32_bf16 v[184:187], a[160:163], v[140:143], v[184:187]
    ds_read_b128 a[112:115], v207 offset:32768
    v_mfma_f32_16x16x32_bf16 v[16:19], a[196:199], v[196:199], v[16:19]
    s_add_u32 s28, s28, 16384
    v_exp_f32 v192, v192
    v_mfma_f32_16x16x32_bf16 v[20:23], a[200:203], v[196:199], v[20:23]
    s_mov_b32 m0, s32
    v_exp_f32 v193, v193
    v_mfma_f32_16x16x32_bf16 v[24:27], a[204:207], v[196:199], v[24:27]
    ds_read_b128 a[116:119], v204 offset:36864
    v_cvt_pk_bf16_f32 v202, v192, v193
    v_mfma_f32_16x16x32_bf16 v[28:31], a[208:211], v[196:199], v[28:31]
    buffer_load_dwordx4 v216, s[12:15], s28 offen offset:0 nt lds
    v_mfma_f32_16x16x32_bf16 a[16:19], a[212:215], v[196:199], a[16:19]
    v_exp_f32 v194, v194
    v_mfma_f32_16x16x32_bf16 a[20:23], a[216:219], v[196:199], a[20:23]
    v_exp_f32 v195, v195
    v_mfma_f32_16x16x32_bf16 a[24:27], a[220:223], v[196:199], a[24:27]
    ds_read_b128 a[120:123], v205 offset:36864
    v_cvt_pk_bf16_f32 v203, v194, v195
    v_mfma_f32_16x16x32_bf16 a[28:31], a[224:227], v[196:199], a[28:31]
    ds_read_b128 a[124:127], v206 offset:36864
    v_mfma_f32_16x16x32_bf16 a[84:87], a[228:231], v[196:199], a[84:87]
    ds_read_b64_tr_b16 a[164:165], v208 offset:32768
    v_mfma_f32_16x16x32_bf16 v[188:191], a[132:135], v[144:147], v[176:179]
    v_exp_f32 v180, v180
    v_mfma_f32_16x16x32_bf16 v[188:191], a[136:139], v[148:151], v[188:191]
    v_exp_f32 v181, v181
    v_mfma_f32_16x16x32_bf16 v[188:191], a[140:143], v[152:155], v[188:191]
    ds_read_b128 a[128:131], v207 offset:36864
    v_cvt_pk_bf16_f32 v196, v180, v181
    v_mfma_f32_16x16x32_bf16 v[188:191], a[144:147], v[156:159], v[188:191]
    buffer_load_dwordx4 v217, s[12:15], s28 offen offset:1024 nt lds
    v_mfma_f32_16x16x32_bf16 v[192:195], a[148:151], v[144:147], v[176:179]
    v_exp_f32 v182, v182
    v_mfma_f32_16x16x32_bf16 v[192:195], a[152:155], v[148:151], v[192:195]
    v_exp_f32 v183, v183
    v_mfma_f32_16x16x32_bf16 v[192:195], a[156:159], v[152:155], v[192:195]
    ds_read_b64_tr_b16 a[166:167], v208 offset:36864
    v_cvt_pk_bf16_f32 v197, v182, v183
    v_mfma_f32_16x16x32_bf16 v[192:195], a[160:163], v[156:159], v[192:195]
    ds_read_b64_tr_b16 a[168:169], v209 offset:32768
    v_mfma_f32_16x16x32_bf16 v[32:35], a[196:199], v[200:203], v[32:35]
    v_exp_f32 v184, v184
    v_mfma_f32_16x16x32_bf16 v[36:39], a[200:203], v[200:203], v[36:39]
    v_exp_f32 v185, v185
    v_mfma_f32_16x16x32_bf16 v[40:43], a[204:207], v[200:203], v[40:43]
    ds_read_b64_tr_b16 a[170:171], v209 offset:36864
    v_cvt_pk_bf16_f32 v198, v184, v185
    v_mfma_f32_16x16x32_bf16 v[44:47], a[208:211], v[200:203], v[44:47]
    ds_read_b64_tr_b16 a[172:173], v210 offset:32768
    v_mfma_f32_16x16x32_bf16 a[32:35], a[212:215], v[200:203], a[32:35]
    v_exp_f32 v186, v186
    v_mfma_f32_16x16x32_bf16 a[36:39], a[216:219], v[200:203], a[36:39]
    v_exp_f32 v187, v187
    v_mfma_f32_16x16x32_bf16 a[40:43], a[220:223], v[200:203], a[40:43]
    ds_read_b64_tr_b16 a[174:175], v210 offset:36864
    v_cvt_pk_bf16_f32 v199, v186, v187
    v_mfma_f32_16x16x32_bf16 a[44:47], a[224:227], v[200:203], a[44:47]
    buffer_load_dwordx4 v216, s[12:15], s28 offen offset:2048 nt lds
    v_mfma_f32_16x16x32_bf16 a[88:91], a[228:231], v[200:203], a[88:91]
    s_waitcnt lgkmcnt(5)
    ds_read_b64_tr_b16 a[176:177], v211 offset:32768
    v_mfma_f32_16x16x32_bf16 v[180:183], a[100:103], v[80:83], v[160:163]
    v_exp_f32 v188, v188
    v_mfma_f32_16x16x32_bf16 v[180:183], a[104:107], v[84:87], v[180:183]
    v_exp_f32 v189, v189
    v_mfma_f32_16x16x32_bf16 v[180:183], a[108:111], v[88:91], v[180:183]
    ds_read_b64_tr_b16 a[178:179], v211 offset:36864
    v_cvt_pk_bf16_f32 v200, v188, v189
    v_mfma_f32_16x16x32_bf16 v[180:183], a[112:115], v[92:95], v[180:183]
    v_add_f32 v250, v250, v188
    v_add_f32 v251, v251, v189
    v_mfma_f32_16x16x32_bf16 v[184:187], a[116:119], v[80:83], v[160:163]
    v_exp_f32 v190, v190
    v_mfma_f32_16x16x32_bf16 v[184:187], a[120:123], v[84:87], v[184:187]
    v_exp_f32 v191, v191
    v_mfma_f32_16x16x32_bf16 v[184:187], a[124:127], v[88:91], v[184:187]
    ds_read_b64_tr_b16 a[180:181], v212 offset:32768
    v_cvt_pk_bf16_f32 v201, v190, v191
    v_mfma_f32_16x16x32_bf16 v[184:187], a[128:131], v[92:95], v[184:187]
    v_add_f32 v250, v250, v190
    v_add_f32 v251, v251, v191
    v_mfma_f32_16x16x32_bf16 v[48:51], a[196:199], v[196:199], v[48:51]
    v_exp_f32 v192, v192
    v_mfma_f32_16x16x32_bf16 v[52:55], a[200:203], v[196:199], v[52:55]
    v_exp_f32 v193, v193
    v_mfma_f32_16x16x32_bf16 v[56:59], a[204:207], v[196:199], v[56:59]
    ds_read_b64_tr_b16 a[182:183], v212 offset:36864
    v_cvt_pk_bf16_f32 v202, v192, v193
    v_mfma_f32_16x16x32_bf16 v[60:63], a[208:211], v[196:199], v[60:63]
    v_add_f32 v250, v250, v192
    v_add_f32 v251, v251, v193
    v_mfma_f32_16x16x32_bf16 a[48:51], a[212:215], v[196:199], a[48:51]
    v_exp_f32 v194, v194
    v_mfma_f32_16x16x32_bf16 a[52:55], a[216:219], v[196:199], a[52:55]
    v_exp_f32 v195, v195
    v_mfma_f32_16x16x32_bf16 a[56:59], a[220:223], v[196:199], a[56:59]
    s_sub_u32 s45, s45, 1
    ds_read_b64_tr_b16 a[184:185], v213 offset:32768
    v_cvt_pk_bf16_f32 v203, v194, v195
    v_mfma_f32_16x16x32_bf16 a[60:63], a[224:227], v[196:199], a[60:63]
    s_cmp_eq_u32 s45, 0
    v_add_f32 v250, v250, v194
    v_add_f32 v251, v251, v195
    v_mfma_f32_16x16x32_bf16 a[92:95], a[228:231], v[196:199], a[92:95]
    buffer_load_dwordx4 v217, s[12:15], s28 offen offset:3072 nt lds
    s_cbranch_scc1 L_tail
    v_mfma_f32_16x16x32_bf16 v[188:191], a[100:103], v[96:99], v[164:167]
    v_exp_f32 v180, v180
    v_mfma_f32_16x16x32_bf16 v[188:191], a[104:107], v[100:103], v[188:191]
    v_exp_f32 v181, v181
    v_mfma_f32_16x16x32_bf16 v[188:191], a[108:111], v[104:107], v[188:191]
    ds_read_b64_tr_b16 a[186:187], v213 offset:36864
    v_cvt_pk_bf16_f32 v196, v180, v181
    v_mfma_f32_16x16x32_bf16 v[188:191], a[112:115], v[108:111], v[188:191]
    ds_read_b64_tr_b16 a[188:189], v214 offset:32768
    v_mfma_f32_16x16x32_bf16 v[192:195], a[116:119], v[96:99], v[164:167]
    v_exp_f32 v182, v182
    v_mfma_f32_16x16x32_bf16 v[192:195], a[120:123], v[100:103], v[192:195]
    s_mov_b32 m0, s36
    v_exp_f32 v183, v183
    v_mfma_f32_16x16x32_bf16 v[192:195], a[124:127], v[104:107], v[192:195]
    ds_read_b64_tr_b16 a[190:191], v214 offset:36864
    v_cvt_pk_bf16_f32 v197, v182, v183
    v_mfma_f32_16x16x32_bf16 v[192:195], a[128:131], v[108:111], v[192:195]
    buffer_load_dwordx4 v216, s[16:19], s28 offen offset:0 nt lds
    v_mfma_f32_16x16x32_bf16 v[64:67], a[196:199], v[200:203], v[64:67]
    v_exp_f32 v184, v184
    v_mfma_f32_16x16x32_bf16 v[68:71], a[200:203], v[200:203], v[68:71]
    v_exp_f32 v185, v185
    v_mfma_f32_16x16x32_bf16 v[72:75], a[204:207], v[200:203], v[72:75]
    ds_read_b64_tr_b16 a[192:193], v215 offset:32768
    v_cvt_pk_bf16_f32 v198, v184, v185
    v_mfma_f32_16x16x32_bf16 v[76:79], a[208:211], v[200:203], v[76:79]
    v_mfma_f32_16x16x32_bf16 a[64:67], a[212:215], v[200:203], a[64:67]
    v_exp_f32 v186, v186
    v_mfma_f32_16x16x32_bf16 a[68:71], a[216:219], v[200:203], a[68:71]
    v_exp_f32 v187, v187
    v_mfma_f32_16x16x32_bf16 a[72:75], a[220:223], v[200:203], a[72:75]
    ds_read_b64_tr_b16 a[194:195], v215 offset:36864
    v_cvt_pk_bf16_f32 v199, v186, v187
    v_mfma_f32_16x16x32_bf16 a[76:79], a[224:227], v[200:203], a[76:79]
    buffer_load_dwordx4 v217, s[16:19], s28 offen offset:1024 nt lds
    v_mfma_f32_16x16x32_bf16 v[180:183], a[100:103], v[112:115], v[168:171]
    v_exp_f32 v188, v188
    v_mfma_f32_16x16x32_bf16 v[180:183], a[104:107], v[116:119], v[180:183]
    v_exp_f32 v189, v189
    v_mfma_f32_16x16x32_bf16 v[180:183], a[108:111], v[120:123], v[180:183]
    v_cvt_pk_bf16_f32 v200, v188, v189
    v_mfma_f32_16x16x32_bf16 v[180:183], a[112:115], v[124:127], v[180:183]
    v_mfma_f32_16x16x32_bf16 v[184:187], a[116:119], v[112:115], v[168:171]
    v_exp_f32 v190, v190
    v_mfma_f32_16x16x32_bf16 v[184:187], a[120:123], v[116:119], v[184:187]
    v_exp_f32 v191, v191
    v_mfma_f32_16x16x32_bf16 v[184:187], a[124:127], v[120:123], v[184:187]
    v_cvt_pk_bf16_f32 v201, v190, v191
    v_mfma_f32_16x16x32_bf16 v[184:187], a[128:131], v[124:127], v[184:187]
    s_waitcnt lgkmcnt(0)
    buffer_load_dwordx4 v216, s[16:19], s28 offen offset:2048 nt lds
    v_mfma_f32_16x16x32_bf16 v[0:3], a[164:167], v[196:199], v[0:3]
    v_exp_f32 v192, v192
    v_mfma_f32_16x16x32_bf16 v[4:7], a[168:171], v[196:199], v[4:7]
    v_exp_f32 v193, v193
    v_mfma_f32_16x16x32_bf16 v[8:11], a[172:175], v[196:199], v[8:11]
    v_cvt_pk_bf16_f32 v202, v192, v193
    v_mfma_f32_16x16x32_bf16 v[12:15], a[176:179], v[196:199], v[12:15]
    v_mfma_f32_16x16x32_bf16 a[0:3], a[180:183], v[196:199], a[0:3]
    v_exp_f32 v194, v194
    v_mfma_f32_16x16x32_bf16 a[4:7], a[184:187], v[196:199], a[4:7]
    v_exp_f32 v195, v195
    v_mfma_f32_16x16x32_bf16 a[8:11], a[188:191], v[196:199], a[8:11]
    v_cvt_pk_bf16_f32 v203, v194, v195
    v_mfma_f32_16x16x32_bf16 a[12:15], a[192:195], v[196:199], a[12:15]
    buffer_load_dwordx4 v217, s[16:19], s28 offen offset:3072 nt lds
    v_mfma_f32_16x16x32_bf16 a[80:83], a[228:231], v[196:199], a[80:83]
    s_waitcnt vmcnt(8)
    v_mfma_f32_16x16x32_bf16 v[188:191], a[100:103], v[128:131], v[172:175]
    s_barrier
    v_exp_f32 v180, v180
    v_mfma_f32_16x16x32_bf16 v[188:191], a[104:107], v[132:135], v[188:191]
    v_exp_f32 v181, v181
    v_mfma_f32_16x16x32_bf16 v[188:191], a[108:111], v[136:139], v[188:191]
    ds_read_b128 a[132:135], v204 offset:49152
    v_cvt_pk_bf16_f32 v196, v180, v181
    v_mfma_f32_16x16x32_bf16 v[188:191], a[112:115], v[140:143], v[188:191]
    ds_read_b128 a[136:139], v205 offset:49152
    v_mfma_f32_16x16x32_bf16 v[192:195], a[116:119], v[128:131], v[172:175]
    v_exp_f32 v182, v182
    v_mfma_f32_16x16x32_bf16 v[192:195], a[120:123], v[132:135], v[192:195]
    v_exp_f32 v183, v183
    v_mfma_f32_16x16x32_bf16 v[192:195], a[124:127], v[136:139], v[192:195]
    ds_read_b128 a[140:143], v206 offset:49152
    v_cvt_pk_bf16_f32 v197, v182, v183
    v_mfma_f32_16x16x32_bf16 v[192:195], a[128:131], v[140:143], v[192:195]
    ds_read_b128 a[144:147], v207 offset:49152
    v_mfma_f32_16x16x32_bf16 v[16:19], a[164:167], v[200:203], v[16:19]
    s_add_u32 s28, s28, 16384
    v_exp_f32 v184, v184
    v_mfma_f32_16x16x32_bf16 v[20:23], a[168:171], v[200:203], v[20:23]
    s_mov_b32 m0, s33
    v_exp_f32 v185, v185
    v_mfma_f32_16x16x32_bf16 v[24:27], a[172:175], v[200:203], v[24:27]
    ds_read_b128 a[148:151], v204 offset:53248
    v_cvt_pk_bf16_f32 v198, v184, v185
    v_mfma_f32_16x16x32_bf16 v[28:31], a[176:179], v[200:203], v[28:31]
    buffer_load_dwordx4 v216, s[12:15], s28 offen offset:0 nt lds
    v_mfma_f32_16x16x32_bf16 a[16:19], a[180:183], v[200:203], a[16:19]
    v_exp_f32 v186, v186
    v_mfma_f32_16x16x32_bf16 a[20:23], a[184:187], v[200:203], a[20:23]
    v_exp_f32 v187, v187
    v_mfma_f32_16x16x32_bf16 a[24:27], a[188:191], v[200:203], a[24:27]
    ds_read_b128 a[152:155], v205 offset:53248
    v_cvt_pk_bf16_f32 v199, v186, v187
    v_mfma_f32_16x16x32_bf16 a[28:31], a[192:195], v[200:203], a[28:31]
    ds_read_b128 a[156:159], v206 offset:53248
    v_mfma_f32_16x16x32_bf16 a[84:87], a[228:231], v[200:203], a[84:87]
    ds_read_b64_tr_b16 a[196:197], v208 offset:49152
    v_mfma_f32_16x16x32_bf16 v[180:183], a[100:103], v[144:147], v[176:179]
    v_exp_f32 v188, v188
    v_mfma_f32_16x16x32_bf16 v[180:183], a[104:107], v[148:151], v[180:183]
    v_exp_f32 v189, v189
    v_mfma_f32_16x16x32_bf16 v[180:183], a[108:111], v[152:155], v[180:183]
    ds_read_b128 a[160:163], v207 offset:53248
    v_cvt_pk_bf16_f32 v200, v188, v189
    v_mfma_f32_16x16x32_bf16 v[180:183], a[112:115], v[156:159], v[180:183]
    buffer_load_dwordx4 v217, s[12:15], s28 offen offset:1024 nt lds
    v_mfma_f32_16x16x32_bf16 v[184:187], a[116:119], v[144:147], v[176:179]
    v_exp_f32 v190, v190
    v_mfma_f32_16x16x32_bf16 v[184:187], a[120:123], v[148:151], v[184:187]
    v_exp_f32 v191, v191
    v_mfma_f32_16x16x32_bf16 v[184:187], a[124:127], v[152:155], v[184:187]
    ds_read_b64_tr_b16 a[198:199], v208 offset:53248
    v_cvt_pk_bf16_f32 v201, v190, v191
    v_mfma_f32_16x16x32_bf16 v[184:187], a[128:131], v[156:159], v[184:187]
    ds_read_b64_tr_b16 a[200:201], v209 offset:49152
    v_mfma_f32_16x16x32_bf16 v[32:35], a[164:167], v[196:199], v[32:35]
    v_exp_f32 v192, v192
    v_mfma_f32_16x16x32_bf16 v[36:39], a[168:171], v[196:199], v[36:39]
    v_exp_f32 v193, v193
    v_mfma_f32_16x16x32_bf16 v[40:43], a[172:175], v[196:199], v[40:43]
    ds_read_b64_tr_b16 a[202:203], v209 offset:53248
    v_cvt_pk_bf16_f32 v202, v192, v193
    v_mfma_f32_16x16x32_bf16 v[44:47], a[176:179], v[196:199], v[44:47]
    ds_read_b64_tr_b16 a[204:205], v210 offset:49152
    v_mfma_f32_16x16x32_bf16 a[32:35], a[180:183], v[196:199], a[32:35]
    v_exp_f32 v194, v194
    v_mfma_f32_16x16x32_bf16 a[36:39], a[184:187], v[196:199], a[36:39]
    v_exp_f32 v195, v195
    v_mfma_f32_16x16x32_bf16 a[40:43], a[188:191], v[196:199], a[40:43]
    ds_read_b64_tr_b16 a[206:207], v210 offset:53248
    v_cvt_pk_bf16_f32 v203, v194, v195
    v_mfma_f32_16x16x32_bf16 a[44:47], a[192:195], v[196:199], a[44:47]
    buffer_load_dwordx4 v216, s[12:15], s28 offen offset:2048 nt lds
    v_mfma_f32_16x16x32_bf16 a[88:91], a[228:231], v[196:199], a[88:91]
    s_waitcnt lgkmcnt(5)
    ds_read_b64_tr_b16 a[208:209], v211 offset:49152
    v_mfma_f32_16x16x32_bf16 v[188:191], a[132:135], v[80:83], v[160:163]
    v_exp_f32 v180, v180
    v_mfma_f32_16x16x32_bf16 v[188:191], a[136:139], v[84:87], v[188:191]
    v_exp_f32 v181, v181
    v_mfma_f32_16x16x32_bf16 v[188:191], a[140:143], v[88:91], v[188:191]
    ds_read_b64_tr_b16 a[210:211], v211 offset:53248
    v_cvt_pk_bf16_f32 v196, v180, v181
    v_mfma_f32_16x16x32_bf16 v[188:191], a[144:147], v[92:95], v[188:191]
    v_add_f32 v250, v250, v180
    v_add_f32 v251, v251, v181
    v_mfma_f32_16x16x32_bf16 v[192:195], a[148:151], v[80:83], v[160:163]
    v_exp_f32 v182, v182
    v_mfma_f32_16x16x32_bf16 v[192:195], a[152:155], v[84:87], v[192:195]
    v_exp_f32 v183, v183
    v_mfma_f32_16x16x32_bf16 v[192:195], a[156:159], v[88:91], v[192:195]
    ds_read_b64_tr_b16 a[212:213], v212 offset:49152
    v_cvt_pk_bf16_f32 v197, v182, v183
    v_mfma_f32_16x16x32_bf16 v[192:195], a[160:163], v[92:95], v[192:195]
    v_add_f32 v250, v250, v182
    v_add_f32 v251, v251, v183
    v_mfma_f32_16x16x32_bf16 v[48:51], a[164:167], v[200:203], v[48:51]
    v_exp_f32 v184, v184
    v_mfma_f32_16x16x32_bf16 v[52:55], a[168:171], v[200:203], v[52:55]
    v_exp_f32 v185, v185
    v_mfma_f32_16x16x32_bf16 v[56:59], a[172:175], v[200:203], v[56:59]
    ds_read_b64_tr_b16 a[214:215], v212 offset:53248
    v_cvt_pk_bf16_f32 v198, v184, v185
    v_mfma_f32_16x16x32_bf16 v[60:63], a[176:179], v[200:203], v[60:63]
    v_add_f32 v250, v250, v184
    v_add_f32 v251, v251, v185
    v_mfma_f32_16x16x32_bf16 a[48:51], a[180:183], v[200:203], a[48:51]
    v_exp_f32 v186, v186
    v_mfma_f32_16x16x32_bf16 a[52:55], a[184:187], v[200:203], a[52:55]
    v_exp_f32 v187, v187
    v_mfma_f32_16x16x32_bf16 a[56:59], a[188:191], v[200:203], a[56:59]
    ds_read_b64_tr_b16 a[216:217], v213 offset:49152
    v_cvt_pk_bf16_f32 v199, v186, v187
    v_mfma_f32_16x16x32_bf16 a[60:63], a[192:195], v[200:203], a[60:63]
    v_add_f32 v250, v250, v186
    v_add_f32 v251, v251, v187
    v_mfma_f32_16x16x32_bf16 a[92:95], a[228:231], v[200:203], a[92:95]
    buffer_load_dwordx4 v217, s[12:15], s28 offen offset:3072 nt lds
    v_mfma_f32_16x16x32_bf16 v[180:183], a[132:135], v[96:99], v[164:167]
    v_exp_f32 v188, v188
    v_mfma_f32_16x16x32_bf16 v[180:183], a[136:139], v[100:103], v[180:183]
    v_exp_f32 v189, v189
    v_mfma_f32_16x16x32_bf16 v[180:183], a[140:143], v[104:107], v[180:183]
    ds_read_b64_tr_b16 a[218:219], v213 offset:53248
    v_cvt_pk_bf16_f32 v200, v188, v189
    v_mfma_f32_16x16x32_bf16 v[180:183], a[144:147], v[108:111], v[180:183]
    ds_read_b64_tr_b16 a[220:221], v214 offset:49152
    v_mfma_f32_16x16x32_bf16 v[184:187], a[148:151], v[96:99], v[164:167]
    v_exp_f32 v190, v190
    v_mfma_f32_16x16x32_bf16 v[184:187], a[152:155], v[100:103], v[184:187]
    s_mov_b32 m0, s37
    v_exp_f32 v191, v191
    v_mfma_f32_16x16x32_bf16 v[184:187], a[156:159], v[104:107], v[184:187]
    ds_read_b64_tr_b16 a[222:223], v214 offset:53248
    v_cvt_pk_bf16_f32 v201, v190, v191
    v_mfma_f32_16x16x32_bf16 v[184:187], a[160:163], v[108:111], v[184:187]
    buffer_load_dwordx4 v216, s[16:19], s28 offen offset:0 nt lds
    v_mfma_f32_16x16x32_bf16 v[64:67], a[164:167], v[196:199], v[64:67]
    v_exp_f32 v192, v192
    v_mfma_f32_16x16x32_bf16 v[68:71], a[168:171], v[196:199], v[68:71]
    v_exp_f32 v193, v193
    v_mfma_f32_16x16x32_bf16 v[72:75], a[172:175], v[196:199], v[72:75]
    ds_read_b64_tr_b16 a[224:225], v215 offset:49152
    v_cvt_pk_bf16_f32 v202, v192, v193
    v_mfma_f32_16x16x32_bf16 v[76:79], a[176:179], v[196:199], v[76:79]
    v_mfma_f32_16x16x32_bf16 a[64:67], a[180:183], v[196:199], a[64:67]
    v_exp_f32 v194, v194
    v_mfma_f32_16x16x32_bf16 a[68:71], a[184:187], v[196:199], a[68:71]
    v_exp_f32 v195, v195
    v_mfma_f32_16x16x32_bf16 a[72:75], a[188:191], v[196:199], a[72:75]
    ds_read_b64_tr_b16 a[226:227], v215 offset:53248
    v_cvt_pk_bf16_f32 v203, v194, v195
    v_mfma_f32_16x16x32_bf16 a[76:79], a[192:195], v[196:199], a[76:79]
    buffer_load_dwordx4 v217, s[16:19], s28 offen offset:1024 nt lds
    v_mfma_f32_16x16x32_bf16 v[188:191], a[132:135], v[112:115], v[168:171]
    v_exp_f32 v180, v180
    v_mfma_f32_16x16x32_bf16 v[188:191], a[136:139], v[116:119], v[188:191]
    v_exp_f32 v181, v181
    v_mfma_f32_16x16x32_bf16 v[188:191], a[140:143], v[120:123], v[188:191]
    v_cvt_pk_bf16_f32 v196, v180, v181
    v_mfma_f32_16x16x32_bf16 v[188:191], a[144:147], v[124:127], v[188:191]
    v_mfma_f32_16x16x32_bf16 v[192:195], a[148:151], v[112:115], v[168:171]
    v_exp_f32 v182, v182
    v_mfma_f32_16x16x32_bf16 v[192:195], a[152:155], v[116:119], v[192:195]
    v_exp_f32 v183, v183
    v_mfma_f32_16x16x32_bf16 v[192:195], a[156:159], v[120:123], v[192:195]
    v_cvt_pk_bf16_f32 v197, v182, v183
    v_mfma_f32_16x16x32_bf16 v[192:195], a[160:163], v[124:127], v[192:195]
    s_waitcnt lgkmcnt(0)
    buffer_load_dwordx4 v216, s[16:19], s28 offen offset:2048 nt lds
    v_mfma_f32_16x16x32_bf16 v[0:3], a[196:199], v[200:203], v[0:3]
    v_exp_f32 v184, v184
    v_mfma_f32_16x16x32_bf16 v[4:7], a[200:203], v[200:203], v[4:7]
    v_exp_f32 v185, v185
    v_mfma_f32_16x16x32_bf16 v[8:11], a[204:207], v[200:203], v[8:11]
    v_cvt_pk_bf16_f32 v198, v184, v185
    v_mfma_f32_16x16x32_bf16 v[12:15], a[208:211], v[200:203], v[12:15]
    v_mfma_f32_16x16x32_bf16 a[0:3], a[212:215], v[200:203], a[0:3]
    v_exp_f32 v186, v186
    v_mfma_f32_16x16x32_bf16 a[4:7], a[216:219], v[200:203], a[4:7]
    v_exp_f32 v187, v187
    v_mfma_f32_16x16x32_bf16 a[8:11], a[220:223], v[200:203], a[8:11]
    v_cvt_pk_bf16_f32 v199, v186, v187
    v_mfma_f32_16x16x32_bf16 a[12:15], a[224:227], v[200:203], a[12:15]
    buffer_load_dwordx4 v217, s[16:19], s28 offen offset:3072 nt lds
    v_mfma_f32_16x16x32_bf16 a[80:83], a[228:231], v[200:203], a[80:83]
    s_waitcnt vmcnt(8)
    v_mfma_f32_16x16x32_bf16 v[180:183], a[132:135], v[128:131], v[172:175]
    s_barrier
    v_exp_f32 v188, v188
    v_mfma_f32_16x16x32_bf16 v[180:183], a[136:139], v[132:135], v[180:183]
    v_exp_f32 v189, v189
    v_mfma_f32_16x16x32_bf16 v[180:183], a[140:143], v[136:139], v[180:183]
    ds_read_b128 a[100:103], v204 offset:0
    v_cvt_pk_bf16_f32 v200, v188, v189
    v_mfma_f32_16x16x32_bf16 v[180:183], a[144:147], v[140:143], v[180:183]
    ds_read_b128 a[104:107], v205 offset:0
    v_mfma_f32_16x16x32_bf16 v[184:187], a[148:151], v[128:131], v[172:175]
    v_exp_f32 v190, v190
    v_mfma_f32_16x16x32_bf16 v[184:187], a[152:155], v[132:135], v[184:187]
    v_exp_f32 v191, v191
    v_mfma_f32_16x16x32_bf16 v[184:187], a[156:159], v[136:139], v[184:187]
    ds_read_b128 a[108:111], v206 offset:0
    v_cvt_pk_bf16_f32 v201, v190, v191
    v_mfma_f32_16x16x32_bf16 v[184:187], a[160:163], v[140:143], v[184:187]
    ds_read_b128 a[112:115], v207 offset:0
    v_mfma_f32_16x16x32_bf16 v[16:19], a[196:199], v[196:199], v[16:19]
    s_add_u32 s28, s28, 16384
    v_exp_f32 v192, v192
    v_mfma_f32_16x16x32_bf16 v[20:23], a[200:203], v[196:199], v[20:23]
    s_mov_b32 m0, s34
    v_exp_f32 v193, v193
    v_mfma_f32_16x16x32_bf16 v[24:27], a[204:207], v[196:199], v[24:27]
    ds_read_b128 a[116:119], v204 offset:4096
    v_cvt_pk_bf16_f32 v202, v192, v193
    v_mfma_f32_16x16x32_bf16 v[28:31], a[208:211], v[196:199], v[28:31]
    buffer_load_dwordx4 v216, s[12:15], s28 offen offset:0 nt lds
    v_mfma_f32_16x16x32_bf16 a[16:19], a[212:215], v[196:199], a[16:19]
    v_exp_f32 v194, v194
    v_mfma_f32_16x16x32_bf16 a[20:23], a[216:219], v[196:199], a[20:23]
    v_exp_f32 v195, v195
    v_mfma_f32_16x16x32_bf16 a[24:27], a[220:223], v[196:199], a[24:27]
    ds_read_b128 a[120:123], v205 offset:4096
    v_cvt_pk_bf16_f32 v203, v194, v195
    v_mfma_f32_16x16x32_bf16 a[28:31], a[224:227], v[196:199], a[28:31]
    ds_read_b128 a[124:127], v206 offset:4096
    v_mfma_f32_16x16x32_bf16 a[84:87], a[228:231], v[196:199], a[84:87]
    ds_read_b64_tr_b16 a[164:165], v208 offset:0
    v_mfma_f32_16x16x32_bf16 v[188:191], a[132:135], v[144:147], v[176:179]
    v_exp_f32 v180, v180
    v_mfma_f32_16x16x32_bf16 v[188:191], a[136:139], v[148:151], v[188:191]
    v_exp_f32 v181, v181
    v_mfma_f32_16x16x32_bf16 v[188:191], a[140:143], v[152:155], v[188:191]
    ds_read_b128 a[128:131], v207 offset:4096
    v_cvt_pk_bf16_f32 v196, v180, v181
    v_mfma_f32_16x16x32_bf16 v[188:191], a[144:147], v[156:159], v[188:191]
    buffer_load_dwordx4 v217, s[12:15], s28 offen offset:1024 nt lds
    v_mfma_f32_16x16x32_bf16 v[192:195], a[148:151], v[144:147], v[176:179]
    v_exp_f32 v182, v182
    v_mfma_f32_16x16x32_bf16 v[192:195], a[152:155], v[148:151], v[192:195]
    v_exp_f32 v183, v183
    v_mfma_f32_16x16x32_bf16 v[192:195], a[156:159], v[152:155], v[192:195]
    ds_read_b64_tr_b16 a[166:167], v208 offset:4096
    v_cvt_pk_bf16_f32 v197, v182, v183
    v_mfma_f32_16x16x32_bf16 v[192:195], a[160:163], v[156:159], v[192:195]
    ds_read_b64_tr_b16 a[168:169], v209 offset:0
    v_mfma_f32_16x16x32_bf16 v[32:35], a[196:199], v[200:203], v[32:35]
    v_exp_f32 v184, v184
    v_mfma_f32_16x16x32_bf16 v[36:39], a[200:203], v[200:203], v[36:39]
    v_exp_f32 v185, v185
    v_mfma_f32_16x16x32_bf16 v[40:43], a[204:207], v[200:203], v[40:43]
    ds_read_b64_tr_b16 a[170:171], v209 offset:4096
    v_cvt_pk_bf16_f32 v198, v184, v185
    v_mfma_f32_16x16x32_bf16 v[44:47], a[208:211], v[200:203], v[44:47]
    ds_read_b64_tr_b16 a[172:173], v210 offset:0
    v_mfma_f32_16x16x32_bf16 a[32:35], a[212:215], v[200:203], a[32:35]
    v_exp_f32 v186, v186
    v_mfma_f32_16x16x32_bf16 a[36:39], a[216:219], v[200:203], a[36:39]
    v_exp_f32 v187, v187
    v_mfma_f32_16x16x32_bf16 a[40:43], a[220:223], v[200:203], a[40:43]
    ds_read_b64_tr_b16 a[174:175], v210 offset:4096
    v_cvt_pk_bf16_f32 v199, v186, v187
    v_mfma_f32_16x16x32_bf16 a[44:47], a[224:227], v[200:203], a[44:47]
    buffer_load_dwordx4 v216, s[12:15], s28 offen offset:2048 nt lds
    v_mfma_f32_16x16x32_bf16 a[88:91], a[228:231], v[200:203], a[88:91]
    s_waitcnt lgkmcnt(5)
    ds_read_b64_tr_b16 a[176:177], v211 offset:0
    v_mfma_f32_16x16x32_bf16 v[180:183], a[100:103], v[80:83], v[160:163]
    v_exp_f32 v188, v188
    v_mfma_f32_16x16x32_bf16 v[180:183], a[104:107], v[84:87], v[180:183]
    v_exp_f32 v189, v189
    v_mfma_f32_16x16x32_bf16 v[180:183], a[108:111], v[88:91], v[180:183]
    ds_read_b64_tr_b16 a[178:179], v211 offset:4096
    v_cvt_pk_bf16_f32 v200, v188, v189
    v_mfma_f32_16x16x32_bf16 v[180:183], a[112:115], v[92:95], v[180:183]
    v_add_f32 v250, v250, v188
    v_add_f32 v251, v251, v189
    v_mfma_f32_16x16x32_bf16 v[184:187], a[116:119], v[80:83], v[160:163]
    v_exp_f32 v190, v190
    v_mfma_f32_16x16x32_bf16 v[184:187], a[120:123], v[84:87], v[184:187]
    v_exp_f32 v191, v191
    v_mfma_f32_16x16x32_bf16 v[184:187], a[124:127], v[88:91], v[184:187]
    ds_read_b64_tr_b16 a[180:181], v212 offset:0
    v_cvt_pk_bf16_f32 v201, v190, v191
    v_mfma_f32_16x16x32_bf16 v[184:187], a[128:131], v[92:95], v[184:187]
    v_add_f32 v250, v250, v190
    v_add_f32 v251, v251, v191
    v_mfma_f32_16x16x32_bf16 v[48:51], a[196:199], v[196:199], v[48:51]
    v_exp_f32 v192, v192
    v_mfma_f32_16x16x32_bf16 v[52:55], a[200:203], v[196:199], v[52:55]
    v_exp_f32 v193, v193
    v_mfma_f32_16x16x32_bf16 v[56:59], a[204:207], v[196:199], v[56:59]
    ds_read_b64_tr_b16 a[182:183], v212 offset:4096
    v_cvt_pk_bf16_f32 v202, v192, v193
    v_mfma_f32_16x16x32_bf16 v[60:63], a[208:211], v[196:199], v[60:63]
    v_add_f32 v250, v250, v192
    v_add_f32 v251, v251, v193
    v_mfma_f32_16x16x32_bf16 a[48:51], a[212:215], v[196:199], a[48:51]
    v_exp_f32 v194, v194
    v_mfma_f32_16x16x32_bf16 a[52:55], a[216:219], v[196:199], a[52:55]
    v_exp_f32 v195, v195
    v_mfma_f32_16x16x32_bf16 a[56:59], a[220:223], v[196:199], a[56:59]
    ds_read_b64_tr_b16 a[184:185], v213 offset:0
    v_cvt_pk_bf16_f32 v203, v194, v195
    v_mfma_f32_16x16x32_bf16 a[60:63], a[224:227], v[196:199], a[60:63]
    v_add_f32 v250, v250, v194
    v_add_f32 v251, v251, v195
    v_mfma_f32_16x16x32_bf16 a[92:95], a[228:231], v[196:199], a[92:95]
    buffer_load_dwordx4 v217, s[12:15], s28 offen offset:3072 nt lds
    s_branch L_loop
L_tail:
    s_mov_b64 s[52:53], 0
    s_waitcnt vmcnt(0)
    v_mfma_f32_16x16x32_bf16 v[188:191], a[100:103], v[96:99], v[164:167]
    s_barrier
    v_exp_f32 v180, v180
    v_mfma_f32_16x16x32_bf16 v[188:191], a[104:107], v[100:103], v[188:191]
    ds_read_b128 a[132:135], v204 offset:49152
    v_exp_f32 v181, v181
    v_mfma_f32_16x16x32_bf16 v[188:191], a[108:111], v[104:107], v[188:191]
    ds_read_b128 a[136:139], v205 offset:49152
    ds_read_b128 a[140:143], v206 offset:49152
    v_cvt_pk_bf16_f32 v196, v180, v181
    v_mfma_f32_16x16x32_bf16 v[188:191], a[112:115], v[108:111], v[188:191]
    ds_read_b128 a[144:147], v207 offset:49152
    ds_read_b128 a[148:151], v204 offset:53248
    ds_read_b128 a[152:155], v205 offset:53248
    v_mfma_f32_16x16x32_bf16 v[192:195], a[116:119], v[96:99], v[164:167]
    ds_read_b128 a[156:159], v206 offset:53248
    v_exp_f32 v182, v182
    v_mfma_f32_16x16x32_bf16 v[192:195], a[120:123], v[100:103], v[192:195]
    ds_read_b128 a[160:163], v207 offset:53248
    v_exp_f32 v183, v183
    v_mfma_f32_16x16x32_bf16 v[192:195], a[124:127], v[104:107], v[192:195]
    ds_read_b64_tr_b16 a[186:187], v213 offset:36864
    ds_read_b64_tr_b16 a[188:189], v214 offset:32768
    v_cvt_pk_bf16_f32 v197, v182, v183
    v_mfma_f32_16x16x32_bf16 v[192:195], a[128:131], v[108:111], v[192:195]
    ds_read_b64_tr_b16 a[190:191], v214 offset:36864
    ds_read_b64_tr_b16 a[192:193], v215 offset:32768
    ds_read_b64_tr_b16 a[194:195], v215 offset:36864
    v_mfma_f32_16x16x32_bf16 v[64:67], a[196:199], v[200:203], v[64:67]
    v_exp_f32 v184, v184
    v_mfma_f32_16x16x32_bf16 v[68:71], a[200:203], v[200:203], v[68:71]
    v_exp_f32 v185, v185
    v_mfma_f32_16x16x32_bf16 v[72:75], a[204:207], v[200:203], v[72:75]
    v_cvt_pk_bf16_f32 v198, v184, v185
    v_mfma_f32_16x16x32_bf16 v[76:79], a[208:211], v[200:203], v[76:79]
    v_mfma_f32_16x16x32_bf16 a[64:67], a[212:215], v[200:203], a[64:67]
    v_exp_f32 v186, v186
    v_mfma_f32_16x16x32_bf16 a[68:71], a[216:219], v[200:203], a[68:71]
    v_exp_f32 v187, v187
    v_mfma_f32_16x16x32_bf16 a[72:75], a[220:223], v[200:203], a[72:75]
    v_cvt_pk_bf16_f32 v199, v186, v187
    v_mfma_f32_16x16x32_bf16 a[76:79], a[224:227], v[200:203], a[76:79]
    s_waitcnt lgkmcnt(5)
    v_mfma_f32_16x16x32_bf16 v[180:183], a[132:135], v[80:83], v[160:163]
    v_exp_f32 v188, v188
    v_mfma_f32_16x16x32_bf16 v[180:183], a[136:139], v[84:87], v[180:183]
    v_exp_f32 v189, v189
    v_mfma_f32_16x16x32_bf16 v[180:183], a[140:143], v[88:91], v[180:183]
    ds_read_b64_tr_b16 a[196:197], v208 offset:49152
    v_cvt_pk_bf16_f32 v200, v188, v189
    v_mfma_f32_16x16x32_bf16 v[180:183], a[144:147], v[92:95], v[180:183]
    ds_read_b64_tr_b16 a[198:199], v208 offset:53248
    ds_read_b64_tr_b16 a[200:201], v209 offset:49152
    v_mfma_f32_16x16x32_bf16 v[184:187], a[148:151], v[80:83], v[160:163]
    v_exp_f32 v190, v190
    v_mfma_f32_16x16x32_bf16 v[184:187], a[152:155], v[84:87], v[184:187]
    v_exp_f32 v191, v191
    v_mfma_f32_16x16x32_bf16 v[184:187], a[156:159], v[88:91], v[184:187]
    v_cvt_pk_bf16_f32 v201, v190, v191
    v_mfma_f32_16x16x32_bf16 v[184:187], a[160:163], v[92:95], v[184:187]
    s_waitcnt lgkmcnt(3)
    ds_read_b64_tr_b16 a[202:203], v209 offset:53248
    ds_read_b64_tr_b16 a[204:205], v210 offset:49152
    v_mfma_f32_16x16x32_bf16 v[0:3], a[164:167], v[196:199], v[0:3]
    v_exp_f32 v192, v192
    v_mfma_f32_16x16x32_bf16 v[4:7], a[168:171], v[196:199], v[4:7]
    v_exp_f32 v193, v193
    v_mfma_f32_16x16x32_bf16 v[8:11], a[172:175], v[196:199], v[8:11]
    ds_read_b64_tr_b16 a[206:207], v210 offset:53248
    v_cvt_pk_bf16_f32 v202, v192, v193
    v_mfma_f32_16x16x32_bf16 v[12:15], a[176:179], v[196:199], v[12:15]
    ds_read_b64_tr_b16 a[208:209], v211 offset:49152
    ds_read_b64_tr_b16 a[210:211], v211 offset:53248
    v_mfma_f32_16x16x32_bf16 a[0:3], a[180:183], v[196:199], a[0:3]
    v_exp_f32 v194, v194
    v_mfma_f32_16x16x32_bf16 a[4:7], a[184:187], v[196:199], a[4:7]
    v_exp_f32 v195, v195
    v_mfma_f32_16x16x32_bf16 a[8:11], a[188:191], v[196:199], a[8:11]
    v_cvt_pk_bf16_f32 v203, v194, v195
    v_mfma_f32_16x16x32_bf16 a[12:15], a[192:195], v[196:199], a[12:15]
    v_mfma_f32_16x16x32_bf16 a[80:83], a[228:231], v[196:199], a[80:83]
    v_mfma_f32_16x16x32_bf16 v[188:191], a[100:103], v[112:115], v[168:171]
    v_exp_f32 v180, v180
    v_mfma_f32_16x16x32_bf16 v[188:191], a[104:107], v[116:119], v[188:191]
    v_exp_f32 v181, v181
    v_mfma_f32_16x16x32_bf16 v[188:191], a[108:111], v[120:123], v[188:191]
    ds_read_b64_tr_b16 a[212:213], v212 offset:49152
    v_cvt_pk_bf16_f32 v196, v180, v181
    v_mfma_f32_16x16x32_bf16 v[188:191], a[112:115], v[124:127], v[188:191]
    ds_read_b64_tr_b16 a[214:215], v212 offset:53248
    ds_read_b64_tr_b16 a[216:217], v213 offset:49152
    v_mfma_f32_16x16x32_bf16 v[192:195], a[116:119], v[112:115], v[168:171]
    v_exp_f32 v182, v182
    v_mfma_f32_16x16x32_bf16 v[192:195], a[120:123], v[116:119], v[192:195]
    v_exp_f32 v183, v183
    v_mfma_f32_16x16x32_bf16 v[192:195], a[124:127], v[120:123], v[192:195]
    ds_read_b64_tr_b16 a[218:219], v213 offset:53248
    v_cvt_pk_bf16_f32 v197, v182, v183
    v_mfma_f32_16x16x32_bf16 v[192:195], a[128:131], v[124:127], v[192:195]
    ds_read_b64_tr_b16 a[220:221], v214 offset:49152
    ds_read_b64_tr_b16 a[222:223], v214 offset:53248
    v_mfma_f32_16x16x32_bf16 v[16:19], a[164:167], v[200:203], v[16:19]
    v_exp_f32 v184, v184
    v_mfma_f32_16x16x32_bf16 v[20:23], a[168:171], v[200:203], v[20:23]
    v_exp_f32 v185, v185
    v_mfma_f32_16x16x32_bf16 v[24:27], a[172:175], v[200:203], v[24:27]
    ds_read_b64_tr_b16 a[224:225], v215 offset:49152
    v_cvt_pk_bf16_f32 v198, v184, v185
    v_mfma_f32_16x16x32_bf16 v[28:31], a[176:179], v[200:203], v[28:31]
    ds_read_b64_tr_b16 a[226:227], v215 offset:53248
    v_mfma_f32_16x16x32_bf16 a[16:19], a[180:183], v[200:203], a[16:19]
    v_exp_f32 v186, v186
    v_mfma_f32_16x16x32_bf16 a[20:23], a[184:187], v[200:203], a[20:23]
    v_exp_f32 v187, v187
    v_mfma_f32_16x16x32_bf16 a[24:27], a[188:191], v[200:203], a[24:27]
    v_cvt_pk_bf16_f32 v199, v186, v187
    v_mfma_f32_16x16x32_bf16 a[28:31], a[192:195], v[200:203], a[28:31]
    v_mfma_f32_16x16x32_bf16 a[84:87], a[228:231], v[200:203], a[84:87]
    v_mfma_f32_16x16x32_bf16 v[180:183], a[132:135], v[96:99], v[164:167]
    v_exp_f32 v188, v188
    v_mfma_f32_16x16x32_bf16 v[180:183], a[136:139], v[100:103], v[180:183]
    v_exp_f32 v189, v189
    v_mfma_f32_16x16x32_bf16 v[180:183], a[140:143], v[104:107], v[180:183]
    v_cvt_pk_bf16_f32 v200, v188, v189
    v_mfma_f32_16x16x32_bf16 v[180:183], a[144:147], v[108:111], v[180:183]
    v_mfma_f32_16x16x32_bf16 v[184:187], a[148:151], v[96:99], v[164:167]
    v_exp_f32 v190, v190
    v_mfma_f32_16x16x32_bf16 v[184:187], a[152:155], v[100:103], v[184:187]
    v_exp_f32 v191, v191
    v_mfma_f32_16x16x32_bf16 v[184:187], a[156:159], v[104:107], v[184:187]
    v_cvt_pk_bf16_f32 v201, v190, v191
    v_mfma_f32_16x16x32_bf16 v[184:187], a[160:163], v[108:111], v[184:187]
    s_waitcnt lgkmcnt(0)
    v_mfma_f32_16x16x32_bf16 v[0:3], a[196:199], v[196:199], v[0:3]
    v_exp_f32 v192, v192
    v_mfma_f32_16x16x32_bf16 v[4:7], a[200:203], v[196:199], v[4:7]
    v_exp_f32 v193, v193
    v_mfma_f32_16x16x32_bf16 v[8:11], a[204:207], v[196:199], v[8:11]
    v_cvt_pk_bf16_f32 v202, v192, v193
    v_mfma_f32_16x16x32_bf16 v[12:15], a[208:211], v[196:199], v[12:15]
    v_mfma_f32_16x16x32_bf16 a[0:3], a[212:215], v[196:199], a[0:3]
    v_exp_f32 v194, v194
    v_mfma_f32_16x16x32_bf16 a[4:7], a[216:219], v[196:199], a[4:7]
    v_exp_f32 v195, v195
    v_mfma_f32_16x16x32_bf16 a[8:11], a[220:223], v[196:199], a[8:11]
    v_cvt_pk_bf16_f32 v203, v194, v195
    v_mfma_f32_16x16x32_bf16 a[12:15], a[224:227], v[196:199], a[12:15]
    v_mfma_f32_16x16x32_bf16 a[80:83], a[228:231], v[196:199], a[80:83]
    v_mfma_f32_16x16x32_bf16 v[188:191], a[100:103], v[128:131], v[172:175]
    v_exp_f32 v180, v180
    v_mfma_f32_16x16x32_bf16 v[188:191], a[104:107], v[132:135], v[188:191]
    v_exp_f32 v181, v181
    v_mfma_f32_16x16x32_bf16 v[188:191], a[108:111], v[136:139], v[188:191]
    ds_write_b128 v255, a[0:3] offset:0
    v_cvt_pk_bf16_f32 v196, v180, v181
    v_mfma_f32_16x16x32_bf16 v[188:191], a[112:115], v[140:143], v[188:191]
    v_mfma_f32_16x16x32_bf16 v[192:195], a[116:119], v[128:131], v[172:175]
    v_exp_f32 v182, v182
    v_mfma_f32_16x16x32_bf16 v[192:195], a[120:123], v[132:135], v[192:195]
    v_exp_f32 v183, v183
    v_mfma_f32_16x16x32_bf16 v[192:195], a[124:127], v[136:139], v[192:195]
    ds_write_b128 v255, a[4:7] offset:1024
    v_cvt_pk_bf16_f32 v197, v182, v183
    v_mfma_f32_16x16x32_bf16 v[192:195], a[128:131], v[140:143], v[192:195]
    ds_write_b32 v240, a80 offset:0
    v_mfma_f32_16x16x32_bf16 v[32:35], a[164:167], v[200:203], v[32:35]
    v_exp_f32 v184, v184
    v_mfma_f32_16x16x32_bf16 v[36:39], a[168:171], v[200:203], v[36:39]
    v_exp_f32 v185, v185
    v_mfma_f32_16x16x32_bf16 v[40:43], a[172:175], v[200:203], v[40:43]
    ds_write_b128 v255, a[8:11] offset:2048
    v_cvt_pk_bf16_f32 v198, v184, v185
    v_mfma_f32_16x16x32_bf16 v[44:47], a[176:179], v[200:203], v[44:47]
    v_mfma_f32_16x16x32_bf16 a[32:35], a[180:183], v[200:203], a[32:35]
    v_exp_f32 v186, v186
    v_mfma_f32_16x16x32_bf16 a[36:39], a[184:187], v[200:203], a[36:39]
    v_exp_f32 v187, v187
    v_mfma_f32_16x16x32_bf16 a[40:43], a[188:191], v[200:203], a[40:43]
    ds_write_b128 v255, a[12:15] offset:3072
    v_cvt_pk_bf16_f32 v199, v186, v187
    v_mfma_f32_16x16x32_bf16 a[44:47], a[192:195], v[200:203], a[44:47]
    v_mfma_f32_16x16x32_bf16 a[88:91], a[228:231], v[200:203], a[88:91]
    v_mfma_f32_16x16x32_bf16 v[180:183], a[132:135], v[112:115], v[168:171]
    v_exp_f32 v188, v188
    v_mfma_f32_16x16x32_bf16 v[180:183], a[136:139], v[116:119], v[180:183]
    v_exp_f32 v189, v189
    v_mfma_f32_16x16x32_bf16 v[180:183], a[140:143], v[120:123], v[180:183]
    v_cvt_pk_bf16_f32 v200, v188, v189
    v_mfma_f32_16x16x32_bf16 v[180:183], a[144:147], v[124:127], v[180:183]
    s_waitcnt lgkmcnt(0)
    v_mfma_f32_16x16x32_bf16 v[184:187], a[148:151], v[112:115], v[168:171]
    s_barrier
    v_exp_f32 v190, v190
    v_mfma_f32_16x16x32_bf16 v[184:187], a[152:155], v[116:119], v[184:187]
    v_exp_f32 v191, v191
    v_mfma_f32_16x16x32_bf16 v[184:187], a[156:159], v[120:123], v[184:187]
    ds_read_b32 v234, v241 offset:0
    v_cvt_pk_bf16_f32 v201, v190, v191
    v_mfma_f32_16x16x32_bf16 v[184:187], a[160:163], v[124:127], v[184:187]
    ds_read_b128 v[80:83], v242 offset:0
    v_mfma_f32_16x16x32_bf16 v[16:19], a[196:199], v[196:199], v[16:19]
    v_exp_f32 v192, v192
    v_mfma_f32_16x16x32_bf16 v[20:23], a[200:203], v[196:199], v[20:23]
    v_exp_f32 v193, v193
    v_mfma_f32_16x16x32_bf16 v[24:27], a[204:207], v[196:199], v[24:27]
    ds_read_b128 v[84:87], v242 offset:1024
    v_cvt_pk_bf16_f32 v202, v192, v193
    v_mfma_f32_16x16x32_bf16 v[28:31], a[208:211], v[196:199], v[28:31]
    ds_read_b128 v[88:91], v242 offset:2048
    v_accvgpr_read_b32 v237, a80
    v_mfma_f32_16x16x32_bf16 a[16:19], a[212:215], v[196:199], a[16:19]
    v_exp_f32 v194, v194
    v_mfma_f32_16x16x32_bf16 a[20:23], a[216:219], v[196:199], a[20:23]
    v_exp_f32 v195, v195
    v_mfma_f32_16x16x32_bf16 a[24:27], a[220:223], v[196:199], a[24:27]
    ds_read_b128 v[92:95], v242 offset:3072
    v_cvt_pk_bf16_f32 v203, v194, v195
    v_mfma_f32_16x16x32_bf16 a[28:31], a[224:227], v[196:199], a[28:31]
    v_mfma_f32_16x16x32_bf16 a[84:87], a[228:231], v[196:199], a[84:87]
    v_mfma_f32_16x16x32_bf16 v[188:191], a[100:103], v[144:147], v[176:179]
    v_exp_f32 v180, v180
    v_mfma_f32_16x16x32_bf16 v[188:191], a[104:107], v[148:151], v[188:191]
    v_exp_f32 v181, v181
    s_waitcnt lgkmcnt(0)
    v_mfma_f32_16x16x32_bf16 v[188:191], a[108:111], v[152:155], v[188:191]
    ds_write_b128 v255, a[16:19] offset:4096
    v_cvt_pk_bf16_f32 v196, v180, v181
    v_mfma_f32_16x16x32_bf16 v[188:191], a[112:115], v[156:159], v[188:191]
    v_add_f32 v237, v237, v234
    v_rcp_f32 v244, v237
    v_mfma_f32_16x16x32_bf16 v[192:195], a[116:119], v[144:147], v[176:179]
    v_exp_f32 v182, v182
    v_mfma_f32_16x16x32_bf16 v[192:195], a[120:123], v[148:151], v[192:195]
    v_exp_f32 v183, v183
    v_mfma_f32_16x16x32_bf16 v[192:195], a[124:127], v[152:155], v[192:195]
    ds_write_b128 v255, a[20:23] offset:5120
    v_cvt_pk_bf16_f32 v197, v182, v183
    v_cmp_nge_f32 vcc, s50, v237
    s_or_b64 s[52:53], s[52:53], vcc
    v_mfma_f32_16x16x32_bf16 v[192:195], a[128:131], v[156:159], v[192:195]
    ds_write_b32 v240, a84 offset:256
    v_add_f32 v0, v0, v80
    v_mfma_f32_16x16x32_bf16 v[48:51], a[164:167], v[200:203], v[48:51]
    v_exp_f32 v184, v184
    v_add_f32 v1, v1, v81
    v_mfma_f32_16x16x32_bf16 v[52:55], a[168:171], v[200:203], v[52:55]
    v_exp_f32 v185, v185
    v_mfma_f32_16x16x32_bf16 v[56:59], a[172:175], v[200:203], v[56:59]
    ds_write_b128 v255, a[24:27] offset:6144
    v_cvt_pk_bf16_f32 v198, v184, v185
    v_mfma_f32_16x16x32_bf16 v[60:63], a[176:179], v[200:203], v[60:63]
    v_add_f32 v2, v2, v82
    v_add_f32 v3, v3, v83
    v_add_f32 v4, v4, v84
    v_mfma_f32_16x16x32_bf16 a[48:51], a[180:183], v[200:203], a[48:51]
    v_exp_f32 v186, v186
    v_mfma_f32_16x16x32_bf16 a[52:55], a[184:187], v[200:203], a[52:55]
    v_exp_f32 v187, v187
    v_mfma_f32_16x16x32_bf16 a[56:59], a[188:191], v[200:203], a[56:59]
    ds_write_b128 v255, a[28:31] offset:7168
    v_cvt_pk_bf16_f32 v199, v186, v187
    v_add_f32 v5, v5, v85
    v_mfma_f32_16x16x32_bf16 a[60:63], a[192:195], v[200:203], a[60:63]
    v_add_f32 v6, v6, v86
    v_add_f32 v7, v7, v87
    v_mfma_f32_16x16x32_bf16 a[92:95], a[228:231], v[200:203], a[92:95]
    v_add_f32 v8, v8, v88
    v_add_f32 v9, v9, v89
    v_add_f32 v10, v10, v90
    v_mfma_f32_16x16x32_bf16 v[180:183], a[132:135], v[128:131], v[172:175]
    v_exp_f32 v188, v188
    v_mfma_f32_16x16x32_bf16 v[180:183], a[136:139], v[132:135], v[180:183]
    v_exp_f32 v189, v189
    v_add_f32 v11, v11, v91
    v_add_f32 v12, v12, v92
    v_mfma_f32_16x16x32_bf16 v[180:183], a[140:143], v[136:139], v[180:183]
    v_cvt_pk_bf16_f32 v200, v188, v189
    v_add_f32 v13, v13, v93
    v_add_f32 v14, v14, v94
    v_add_f32 v15, v15, v95
    v_mfma_f32_16x16x32_bf16 v[180:183], a[144:147], v[140:143], v[180:183]
    s_waitcnt lgkmcnt(0)
    v_add_f32 v250, v250, v188
    v_add_f32 v251, v251, v189
    v_mul_f32 v0, v0, v244
    v_mul_f32 v1, v1, v244
    v_mfma_f32_16x16x32_bf16 v[184:187], a[148:151], v[128:131], v[172:175]
    s_barrier
    v_exp_f32 v190, v190
    v_mul_f32 v2, v2, v244
    v_mul_f32 v3, v3, v244
    v_mfma_f32_16x16x32_bf16 v[184:187], a[152:155], v[132:135], v[184:187]
    v_exp_f32 v191, v191
    v_mul_f32 v4, v4, v244
    v_mul_f32 v5, v5, v244
    v_mfma_f32_16x16x32_bf16 v[184:187], a[156:159], v[136:139], v[184:187]
    ds_read_b32 v235, v241 offset:256
    v_cvt_pk_bf16_f32 v201, v190, v191
    v_mul_f32 v6, v6, v244
    v_mul_f32 v7, v7, v244
    v_mul_f32 v8, v8, v244
    v_mfma_f32_16x16x32_bf16 v[184:187], a[160:163], v[140:143], v[184:187]
    ds_read_b128 v[96:99], v242 offset:4096
    v_add_f32 v250, v250, v190
    v_add_f32 v251, v251, v191
    v_mul_f32 v9, v9, v244
    v_mul_f32 v10, v10, v244
    v_mfma_f32_16x16x32_bf16 v[32:35], a[196:199], v[196:199], v[32:35]
    v_exp_f32 v192, v192
    v_mul_f32 v11, v11, v244
    v_mul_f32 v12, v12, v244
    v_mfma_f32_16x16x32_bf16 v[36:39], a[200:203], v[196:199], v[36:39]
    v_exp_f32 v193, v193
    v_mul_f32 v13, v13, v244
    v_mul_f32 v14, v14, v244
    v_mfma_f32_16x16x32_bf16 v[40:43], a[204:207], v[196:199], v[40:43]
    ds_read_b128 v[100:103], v242 offset:5120
    v_cvt_pk_bf16_f32 v202, v192, v193
    v_mul_f32 v15, v15, v244
    v_cvt_pk_bf16_f32 v80, v0, v1
    v_mfma_f32_16x16x32_bf16 v[44:47], a[208:211], v[196:199], v[44:47]
    ds_read_b128 v[104:107], v242 offset:6144
    v_add_f32 v250, v250, v192
    v_add_f32 v251, v251, v193
    v_cvt_pk_bf16_f32 v81, v2, v3
    v_cvt_pk_bf16_f32 v82, v4, v5
    v_cvt_pk_bf16_f32 v83, v6, v7
    v_mfma_f32_16x16x32_bf16 a[32:35], a[212:215], v[196:199], a[32:35]
    v_exp_f32 v194, v194
    v_cvt_pk_bf16_f32 v88, v8, v9
    v_cvt_pk_bf16_f32 v89, v10, v11
    v_mfma_f32_16x16x32_bf16 a[36:39], a[216:219], v[196:199], a[36:39]
    v_exp_f32 v195, v195
    v_cvt_pk_bf16_f32 v90, v12, v13
    v_cvt_pk_bf16_f32 v91, v14, v15
    v_mfma_f32_16x16x32_bf16 a[40:43], a[220:223], v[196:199], a[40:43]
    ds_read_b128 v[108:111], v242 offset:7168
    v_cvt_pk_bf16_f32 v203, v194, v195
    v_permlane16_swap_b32 v80, v82
    v_permlane16_swap_b32 v81, v83
    v_mfma_f32_16x16x32_bf16 a[44:47], a[224:227], v[196:199], a[44:47]
    v_add_f32 v250, v250, v194
    v_add_f32 v251, v251, v195
    v_permlane16_swap_b32 v88, v90
    v_permlane16_swap_b32 v89, v91
    v_mfma_f32_16x16x32_bf16 a[88:91], a[228:231], v[196:199], a[88:91]
    buffer_store_dwordx4 v[80:83], v254, s[24:27], s40 offen offset:0 sc0 sc1
    buffer_store_dwordx4 v[88:91], v254, s[24:27], s40 offen offset:64 sc0 sc1
    v_accvgpr_read_b32 v238, a84
    v_mfma_f32_16x16x32_bf16 v[188:191], a[132:135], v[144:147], v[176:179]
    v_exp_f32 v180, v180
    v_mfma_f32_16x16x32_bf16 v[188:191], a[136:139], v[148:151], v[188:191]
    v_exp_f32 v181, v181
    s_waitcnt lgkmcnt(0)
    v_mfma_f32_16x16x32_bf16 v[188:191], a[140:143], v[152:155], v[188:191]
    ds_write_b128 v255, a[32:35] offset:8192
    v_cvt_pk_bf16_f32 v196, v180, v181
    v_add_f32 v238, v238, v235
    v_mfma_f32_16x16x32_bf16 v[188:191], a[144:147], v[156:159], v[188:191]
    v_rcp_f32 v246, v238
    v_mfma_f32_16x16x32_bf16 v[192:195], a[148:151], v[144:147], v[176:179]
    v_exp_f32 v182, v182
    v_cmp_nge_f32 vcc, s50, v238
    s_or_b64 s[52:53], s[52:53], vcc
    v_mfma_f32_16x16x32_bf16 v[192:195], a[152:155], v[148:151], v[192:195]
    v_exp_f32 v183, v183
    v_mfma_f32_16x16x32_bf16 v[192:195], a[156:159], v[152:155], v[192:195]
    ds_write_b128 v255, a[36:39] offset:9216
    v_cvt_pk_bf16_f32 v197, v182, v183
    v_add_f32 v16, v16, v96
    v_mfma_f32_16x16x32_bf16 v[192:195], a[160:163], v[156:159], v[192:195]
    ds_write_b32 v240, a88 offset:512
    v_add_f32 v17, v17, v97
    v_mfma_f32_16x16x32_bf16 v[64:67], a[164:167], v[200:203], v[64:67]
    v_exp_f32 v184, v184
    v_add_f32 v18, v18, v98
    v_mfma_f32_16x16x32_bf16 v[68:71], a[168:171], v[200:203], v[68:71]
    v_exp_f32 v185, v185
    v_mfma_f32_16x16x32_bf16 v[72:75], a[172:175], v[200:203], v[72:75]
    ds_write_b128 v255, a[40:43] offset:10240
    v_cvt_pk_bf16_f32 v198, v184, v185
    v_add_f32 v19, v19, v99
    v_mfma_f32_16x16x32_bf16 v[76:79], a[176:179], v[200:203], v[76:79]
    v_add_f32 v20, v20, v100
    v_add_f32 v21, v21, v101
    v_mfma_f32_16x16x32_bf16 a[64:67], a[180:183], v[200:203], a[64:67]
    v_exp_f32 v186, v186
    v_add_f32 v22, v22, v102
    v_mfma_f32_16x16x32_bf16 a[68:71], a[184:187], v[200:203], a[68:71]
    v_exp_f32 v187, v187
    v_mfma_f32_16x16x32_bf16 a[72:75], a[188:191], v[200:203], a[72:75]
    ds_write_b128 v255, a[44:47] offset:11264
    v_cvt_pk_bf16_f32 v199, v186, v187
    v_add_f32 v23, v23, v103
    v_mfma_f32_16x16x32_bf16 a[76:79], a[192:195], v[200:203], a[76:79]
    v_add_f32 v24, v24, v104
    v_add_f32 v25, v25, v105
    v_add_f32 v26, v26, v106
    v_mfma_f32_16x16x32_bf16 v[48:51], a[196:199], v[196:199], v[48:51]
    v_exp_f32 v188, v188
    v_exp_f32 v189, v189
    s_nop 0
    v_cvt_pk_bf16_f32 v200, v188, v189
    v_mfma_f32_16x16x32_bf16 v[52:55], a[200:203], v[196:199], v[52:55]
    s_waitcnt lgkmcnt(0)
    v_add_f32 v250, v250, v188
    v_add_f32 v251, v251, v189
    v_exp_f32 v190, v190
    v_add_f32 v27, v27, v107
    v_add_f32 v28, v28, v108
    v_add_f32 v29, v29, v109
    v_add_f32 v30, v30, v110
    v_mfma_f32_16x16x32_bf16 v[56:59], a[204:207], v[196:199], v[56:59]
    s_barrier
    v_exp_f32 v191, v191
    s_nop 0
    v_cvt_pk_bf16_f32 v201, v190, v191
    v_add_f32 v250, v250, v190
    v_add_f32 v31, v31, v111
    v_mul_f32 v16, v16, v246
    v_mul_f32 v17, v17, v246
    v_mul_f32 v18, v18, v246
    v_mfma_f32_16x16x32_bf16 v[60:63], a[208:211], v[196:199], v[60:63]
    ds_read_b32 v236, v241 offset:512
    v_add_f32 v251, v251, v191
    v_exp_f32 v192, v192
    v_exp_f32 v193, v193
    v_mul_f32 v19, v19, v246
    v_mul_f32 v20, v20, v246
    v_mul_f32 v21, v21, v246
    v_mul_f32 v22, v22, v246
    v_mul_f32 v23, v23, v246
    v_mfma_f32_16x16x32_bf16 a[48:51], a[212:215], v[196:199], a[48:51]
    ds_read_b128 v[112:115], v242 offset:8192
    v_cvt_pk_bf16_f32 v202, v192, v193
    v_add_f32 v250, v250, v192
    v_add_f32 v251, v251, v193
    v_mul_f32 v24, v24, v246
    v_mul_f32 v25, v25, v246
    v_mul_f32 v26, v26, v246
    v_mul_f32 v27, v27, v246
    v_mfma_f32_16x16x32_bf16 a[52:55], a[216:219], v[196:199], a[52:55]
    ds_read_b128 v[116:119], v242 offset:9216
    v_exp_f32 v194, v194
    v_exp_f32 v195, v195
    s_nop 0
    v_cvt_pk_bf16_f32 v203, v194, v195
    v_mul_f32 v28, v28, v246
    v_mul_f32 v29, v29, v246
    v_mul_f32 v30, v30, v246
    v_mul_f32 v31, v31, v246
    v_mfma_f32_16x16x32_bf16 a[56:59], a[220:223], v[196:199], a[56:59]
    ds_read_b128 v[120:123], v242 offset:10240
    v_add_f32 v250, v250, v194
    v_add_f32 v251, v251, v195
    v_cvt_pk_bf16_f32 v96, v16, v17
    v_cvt_pk_bf16_f32 v97, v18, v19
    v_cvt_pk_bf16_f32 v98, v20, v21
    v_cvt_pk_bf16_f32 v99, v22, v23
    v_cvt_pk_bf16_f32 v104, v24, v25
    v_mfma_f32_16x16x32_bf16 a[60:63], a[224:227], v[196:199], a[60:63]
    ds_read_b128 v[124:127], v242 offset:11264
    v_cvt_pk_bf16_f32 v105, v26, v27
    v_cvt_pk_bf16_f32 v106, v28, v29
    v_cvt_pk_bf16_f32 v107, v30, v31
    v_permlane16_swap_b32 v96, v98
    v_permlane16_swap_b32 v97, v99
    v_mfma_f32_16x16x32_bf16 a[92:95], a[228:231], v[196:199], a[92:95]
    v_permlane16_swap_b32 v104, v106
    v_permlane16_swap_b32 v105, v107
    buffer_store_dwordx4 v[96:99], v254, s[24:27], s41 offen offset:0 sc0 sc1
    buffer_store_dwordx4 v[104:107], v254, s[24:27], s41 offen offset:64 sc0 sc1
    v_accvgpr_read_b32 v239, a88
    v_mfma_f32_16x16x32_bf16 v[64:67], a[196:199], v[200:203], v[64:67]
    v_mfma_f32_16x16x32_bf16 v[68:71], a[200:203], v[200:203], v[68:71]
    ds_write_b128 v255, a[48:51] offset:12288
    s_waitcnt lgkmcnt(5)
    v_add_f32 v239, v239, v236
    v_mfma_f32_16x16x32_bf16 v[72:75], a[204:207], v[200:203], v[72:75]
    v_rcp_f32 v230, v239
    v_add_f32 v219, v250, v251
    v_mfma_f32_16x16x32_bf16 v[76:79], a[208:211], v[200:203], v[76:79]
    ds_write_b128 v255, a[52:55] offset:13312
    v_mov_b32 v220, v219
    v_accvgpr_read_b32 v218, a92
    v_mfma_f32_16x16x32_bf16 a[64:67], a[212:215], v[200:203], a[64:67]
    v_cmp_nge_f32 vcc, s50, v239
    s_or_b64 s[52:53], s[52:53], vcc
    v_permlane16_swap_b32 v219, v220
    v_add_f32 v219, v219, v220
    v_mfma_f32_16x16x32_bf16 a[68:71], a[216:219], v[200:203], a[68:71]
    ds_write_b128 v255, a[56:59] offset:14336
    v_mov_b32 v220, v219
    v_cmp_nge_f32 vcc, s50, v218
    s_or_b64 s[52:53], s[52:53], vcc
    v_mfma_f32_16x16x32_bf16 a[72:75], a[220:223], v[200:203], a[72:75]
    ds_write_b32 v240, v218 offset:768
    v_permlane32_swap_b32 v219, v220
    v_add_f32 v219, v219, v220
    v_mfma_f32_16x16x32_bf16 a[76:79], a[224:227], v[200:203], a[76:79]
    ds_write_b128 v255, a[60:63] offset:15360
    v_cmp_nge_f32 vcc, s50, v219
    s_or_b64 s[52:53], s[52:53], vcc
    ds_write_b32 v240, v219 offset:1024
    s_cmp_lg_u64 s[52:53], 0
    s_cselect_b32 s54, 1, 0
    s_lshl_b32 s56, s3, 2
    s_add_u32 s56, s56, 46080
    v_mov_b32 v220, s56
    v_mov_b32 v221, s54
    ds_write_b32 v220, v221
    s_waitcnt lgkmcnt(7)
    v_pk_add_f32 v[32:33], v[32:33], v[112:113]
    v_pk_add_f32 v[34:35], v[34:35], v[114:115]
    v_pk_add_f32 v[36:37], v[36:37], v[116:117]
    v_pk_add_f32 v[38:39], v[38:39], v[118:119]
    v_pk_add_f32 v[40:41], v[40:41], v[120:121]
    v_pk_add_f32 v[42:43], v[42:43], v[122:123]
    v_pk_add_f32 v[44:45], v[44:45], v[124:125]
    v_pk_add_f32 v[46:47], v[46:47], v[126:127]
    ds_write_b128 v255, a[64:67] offset:16384
    ds_write_b128 v255, a[68:71] offset:17408
    ds_write_b128 v255, a[72:75] offset:18432
    ds_write_b128 v255, a[76:79] offset:19456
    v_pk_mul_f32 v[32:33], v[32:33], v[230:231] op_sel_hi:[1,0]
    v_pk_mul_f32 v[34:35], v[34:35], v[230:231] op_sel_hi:[1,0]
    v_pk_mul_f32 v[36:37], v[36:37], v[230:231] op_sel_hi:[1,0]
    v_pk_mul_f32 v[38:39], v[38:39], v[230:231] op_sel_hi:[1,0]
    v_pk_mul_f32 v[40:41], v[40:41], v[230:231] op_sel_hi:[1,0]
    v_pk_mul_f32 v[42:43], v[42:43], v[230:231] op_sel_hi:[1,0]
    v_pk_mul_f32 v[44:45], v[44:45], v[230:231] op_sel_hi:[1,0]
    v_pk_mul_f32 v[46:47], v[46:47], v[230:231] op_sel_hi:[1,0]
    v_cvt_pk_bf16_f32 v112, v32, v33
    v_cvt_pk_bf16_f32 v113, v34, v35
    v_cvt_pk_bf16_f32 v114, v36, v37
    v_cvt_pk_bf16_f32 v115, v38, v39
    v_cvt_pk_bf16_f32 v120, v40, v41
    v_cvt_pk_bf16_f32 v121, v42, v43
    v_cvt_pk_bf16_f32 v122, v44, v45
    v_cvt_pk_bf16_f32 v123, v46, v47
    s_nop 0
    v_permlane16_swap_b32 v112, v114
    v_permlane16_swap_b32 v113, v115
    v_permlane16_swap_b32 v120, v122
    v_permlane16_swap_b32 v121, v123
    buffer_store_dwordx4 v[112:115], v254, s[24:27], s42 offen offset:0 sc0 sc1
    buffer_store_dwordx4 v[120:123], v254, s[24:27], s42 offen offset:64 sc0 sc1
    s_waitcnt lgkmcnt(0)
    s_barrier
    v_mov_b32 v226, 46080
    ds_read_b128 v[222:225], v226
    ds_read_b32 v227, v241 offset:768
    ds_read_b32 v228, v241 offset:1024
    ds_read_b128 v[128:131], v242 offset:12288
    ds_read_b128 v[132:135], v242 offset:13312
    ds_read_b128 v[136:139], v242 offset:14336
    ds_read_b128 v[140:143], v242 offset:15360
    ds_read_b128 v[144:147], v242 offset:16384
    ds_read_b128 v[148:151], v242 offset:17408
    ds_read_b128 v[152:155], v242 offset:18432
    ds_read_b128 v[156:159], v242 offset:19456
    s_waitcnt lgkmcnt(10)
    v_or_b32 v222, v222, v223
    v_or_b32 v224, v224, v225
    v_or_b32 v222, v222, v224
    s_nop 0
    v_readfirstlane_b32 s54, v222
    s_waitcnt lgkmcnt(8)
    v_add_f32 v218, v218, v227
    v_add_f32 v219, v219, v228
    v_rcp_f32 v230, v218
    v_rcp_f32 v232, v219
    s_cmp_lg_u32 s54, 0
    s_cbranch_scc1 L_slow
    s_waitcnt lgkmcnt(4)
    v_pk_add_f32 v[48:49], v[48:49], v[128:129]
    v_pk_add_f32 v[50:51], v[50:51], v[130:131]
    v_pk_add_f32 v[52:53], v[52:53], v[132:133]
    v_pk_add_f32 v[54:55], v[54:55], v[134:135]
    v_pk_add_f32 v[56:57], v[56:57], v[136:137]
    v_pk_add_f32 v[58:59], v[58:59], v[138:139]
    v_pk_add_f32 v[60:61], v[60:61], v[140:141]
    v_pk_add_f32 v[62:63], v[62:63], v[142:143]
    v_pk_mul_f32 v[48:49], v[48:49], v[230:231] op_sel_hi:[1,0]
    v_pk_mul_f32 v[50:51], v[50:51], v[230:231] op_sel_hi:[1,0]
    v_pk_mul_f32 v[52:53], v[52:53], v[230:231] op_sel_hi:[1,0]
    v_pk_mul_f32 v[54:55], v[54:55], v[230:231] op_sel_hi:[1,0]
    v_pk_mul_f32 v[56:57], v[56:57], v[230:231] op_sel_hi:[1,0]
    v_pk_mul_f32 v[58:59], v[58:59], v[230:231] op_sel_hi:[1,0]
    v_pk_mul_f32 v[60:61], v[60:61], v[230:231] op_sel_hi:[1,0]
    v_pk_mul_f32 v[62:63], v[62:63], v[230:231] op_sel_hi:[1,0]
    v_cvt_pk_bf16_f32 v128, v48, v49
    v_cvt_pk_bf16_f32 v129, v50, v51
    v_cvt_pk_bf16_f32 v130, v52, v53
    v_cvt_pk_bf16_f32 v131, v54, v55
    v_cvt_pk_bf16_f32 v136, v56, v57
    v_cvt_pk_bf16_f32 v137, v58, v59
    v_cvt_pk_bf16_f32 v138, v60, v61
    v_cvt_pk_bf16_f32 v139, v62, v63
    s_nop 0
    v_permlane16_swap_b32 v128, v130
    v_permlane16_swap_b32 v129, v131
    v_permlane16_swap_b32 v136, v138
    v_permlane16_swap_b32 v137, v139
    buffer_store_dwordx4 v[128:131], v254, s[24:27], s43 offen offset:0 sc0 sc1
    buffer_store_dwordx4 v[136:139], v254, s[24:27], s43 offen offset:64 sc0 sc1
    s_waitcnt lgkmcnt(0)
    v_pk_add_f32 v[64:65], v[64:65], v[144:145]
    v_pk_add_f32 v[66:67], v[66:67], v[146:147]
    v_pk_add_f32 v[68:69], v[68:69], v[148:149]
    v_pk_add_f32 v[70:71], v[70:71], v[150:151]
    v_pk_add_f32 v[72:73], v[72:73], v[152:153]
    v_pk_add_f32 v[74:75], v[74:75], v[154:155]
    v_pk_add_f32 v[76:77], v[76:77], v[156:157]
    v_pk_add_f32 v[78:79], v[78:79], v[158:159]
    v_pk_mul_f32 v[64:65], v[64:65], v[232:233] op_sel_hi:[1,0]
    v_pk_mul_f32 v[66:67], v[66:67], v[232:233] op_sel_hi:[1,0]
    v_pk_mul_f32 v[68:69], v[68:69], v[232:233] op_sel_hi:[1,0]
    v_pk_mul_f32 v[70:71], v[70:71], v[232:233] op_sel_hi:[1,0]
    v_pk_mul_f32 v[72:73], v[72:73], v[232:233] op_sel_hi:[1,0]
    v_pk_mul_f32 v[74:75], v[74:75], v[232:233] op_sel_hi:[1,0]
    v_pk_mul_f32 v[76:77], v[76:77], v[232:233] op_sel_hi:[1,0]
    v_pk_mul_f32 v[78:79], v[78:79], v[232:233] op_sel_hi:[1,0]
    v_cvt_pk_bf16_f32 v144, v64, v65
    v_cvt_pk_bf16_f32 v145, v66, v67
    v_cvt_pk_bf16_f32 v146, v68, v69
    v_cvt_pk_bf16_f32 v147, v70, v71
    v_cvt_pk_bf16_f32 v152, v72, v73
    v_cvt_pk_bf16_f32 v153, v74, v75
    v_cvt_pk_bf16_f32 v154, v76, v77
    v_cvt_pk_bf16_f32 v155, v78, v79
    s_nop 0
    v_permlane16_swap_b32 v144, v146
    v_permlane16_swap_b32 v145, v147
    v_permlane16_swap_b32 v152, v154
    v_permlane16_swap_b32 v153, v155
    buffer_store_dwordx4 v[144:147], v254, s[24:27], s44 offen offset:0 sc0 sc1
    buffer_store_dwordx4 v[152:155], v254, s[24:27], s44 offen offset:64 sc0 sc1
L_done:
    s_endpgm
L_slow:
    s_waitcnt vmcnt(0) lgkmcnt(0)
    s_barrier
    s_lshl_b32 s57, s46, 11
    s_add_u32 m0, s62, 0
    s_add_u32 s58, s57, 0
    buffer_load_dwordx4 v216, s[20:23], s58 offen offset:0 lds
    buffer_load_dwordx4 v217, s[20:23], s58 offen offset:1024 lds
    s_add_u32 m0, s62, 4096
    s_add_u32 s58, s57, 4096
    buffer_load_dwordx4 v216, s[20:23], s58 offen offset:0 lds
    buffer_load_dwordx4 v217, s[20:23], s58 offen offset:1024 lds
    s_add_u32 m0, s62, 8192
    s_add_u32 s58, s57, 8192
    buffer_load_dwordx4 v216, s[20:23], s58 offen offset:0 lds
    buffer_load_dwordx4 v217, s[20:23], s58 offen offset:1024 lds
    s_add_u32 m0, s62, 12288
    s_add_u32 s58, s57, 12288
    buffer_load_dwordx4 v216, s[20:23], s58 offen offset:0 lds
    buffer_load_dwordx4 v217, s[20:23], s58 offen offset:1024 lds
    s_add_u32 m0, s62, 16384
    s_add_u32 s58, s57, 16384
    buffer_load_dwordx4 v216, s[20:23], s58 offen offset:0 lds
    buffer_load_dwordx4 v217, s[20:23], s58 offen offset:1024 lds
    s_mul_i32 s57, s47, 20480
    s_add_u32 s57, s57, 114688
    s_sub_u32 s57, s57, s61
    v_add_u32 v222, s57, v204
    v_add_u32 v223, s57, v205
    v_add_u32 v224, s57, v206
    v_add_u32 v225, s57, v207
    s_waitcnt vmcnt(0)
    s_barrier
    ds_read_b128 v[80:83], v222 offset:0
    ds_read_b128 v[84:87], v223 offset:0
    ds_read_b128 v[88:91], v224 offset:0
    ds_read_b128 v[92:95], v225 offset:0
    s_waitcnt lgkmcnt(0)
    v_lshlrev_b32 v230, 16, v80
    v_and_b32 v231, 0xffff0000, v80
    v_pk_mul_f32 v[230:231], v[230:231], s[48:49]
    v_cvt_pk_bf16_f32 v80, v230, v231
    v_lshlrev_b32 v232, 16, v81
    v_and_b32 v233, 0xffff0000, v81
    v_pk_mul_f32 v[232:233], v[232:233], s[48:49]
    v_cvt_pk_bf16_f32 v81, v232, v233
    v_lshlrev_b32 v234, 16, v82
    v_and_b32 v235, 0xffff0000, v82
    v_pk_mul_f32 v[234:235], v[234:235], s[48:49]
    v_cvt_pk_bf16_f32 v82, v234, v235
    v_lshlrev_b32 v236, 16, v83
    v_and_b32 v237, 0xffff0000, v83
    v_pk_mul_f32 v[236:237], v[236:237], s[48:49]
    v_cvt_pk_bf16_f32 v83, v236, v237
    v_lshlrev_b32 v230, 16, v84
    v_and_b32 v231, 0xffff0000, v84
    v_pk_mul_f32 v[230:231], v[230:231], s[48:49]
    v_cvt_pk_bf16_f32 v84, v230, v231
    v_lshlrev_b32 v232, 16, v85
    v_and_b32 v233, 0xffff0000, v85
    v_pk_mul_f32 v[232:233], v[232:233], s[48:49]
    v_cvt_pk_bf16_f32 v85, v232, v233
    v_lshlrev_b32 v234, 16, v86
    v_and_b32 v235, 0xffff0000, v86
    v_pk_mul_f32 v[234:235], v[234:235], s[48:49]
    v_cvt_pk_bf16_f32 v86, v234, v235
    v_lshlrev_b32 v236, 16, v87
    v_and_b32 v237, 0xffff0000, v87
    v_pk_mul_f32 v[236:237], v[236:237], s[48:49]
    v_cvt_pk_bf16_f32 v87, v236, v237
    v_lshlrev_b32 v230, 16, v88
    v_and_b32 v231, 0xffff0000, v88
    v_pk_mul_f32 v[230:231], v[230:231], s[48:49]
    v_cvt_pk_bf16_f32 v88, v230, v231
    v_lshlrev_b32 v232, 16, v89
    v_and_b32 v233, 0xffff0000, v89
    v_pk_mul_f32 v[232:233], v[232:233], s[48:49]
    v_cvt_pk_bf16_f32 v89, v232, v233
    v_lshlrev_b32 v234, 16, v90
    v_and_b32 v235, 0xffff0000, v90
    v_pk_mul_f32 v[234:235], v[234:235], s[48:49]
    v_cvt_pk_bf16_f32 v90, v234, v235
    v_lshlrev_b32 v236, 16, v91
    v_and_b32 v237, 0xffff0000, v91
    v_pk_mul_f32 v[236:237], v[236:237], s[48:49]
    v_cvt_pk_bf16_f32 v91, v236, v237
    v_lshlrev_b32 v230, 16, v92
    v_and_b32 v231, 0xffff0000, v92
    v_pk_mul_f32 v[230:231], v[230:231], s[48:49]
    v_cvt_pk_bf16_f32 v92, v230, v231
    v_lshlrev_b32 v232, 16, v93
    v_and_b32 v233, 0xffff0000, v93
    v_pk_mul_f32 v[232:233], v[232:233], s[48:49]
    v_cvt_pk_bf16_f32 v93, v232, v233
    v_lshlrev_b32 v234, 16, v94
    v_and_b32 v235, 0xffff0000, v94
    v_pk_mul_f32 v[234:235], v[234:235], s[48:49]
    v_cvt_pk_bf16_f32 v94, v234, v235
    v_lshlrev_b32 v236, 16, v95
    v_and_b32 v237, 0xffff0000, v95
    v_pk_mul_f32 v[236:237], v[236:237], s[48:49]
    v_cvt_pk_bf16_f32 v95, v236, v237
    ds_read_b128 v[96:99], v222 offset:4096
    ds_read_b128 v[100:103], v223 offset:4096
    ds_read_b128 v[104:107], v224 offset:4096
    ds_read_b128 v[108:111], v225 offset:4096
    s_waitcnt lgkmcnt(0)
    v_lshlrev_b32 v230, 16, v96
    v_and_b32 v231, 0xffff0000, v96
    v_pk_mul_f32 v[230:231], v[230:231], s[48:49]
    v_cvt_pk_bf16_f32 v96, v230, v231
    v_lshlrev_b32 v232, 16, v97
    v_and_b32 v233, 0xffff0000, v97
    v_pk_mul_f32 v[232:233], v[232:233], s[48:49]
    v_cvt_pk_bf16_f32 v97, v232, v233
    v_lshlrev_b32 v234, 16, v98
    v_and_b32 v235, 0xffff0000, v98
    v_pk_mul_f32 v[234:235], v[234:235], s[48:49]
    v_cvt_pk_bf16_f32 v98, v234, v235
    v_lshlrev_b32 v236, 16, v99
    v_and_b32 v237, 0xffff0000, v99
    v_pk_mul_f32 v[236:237], v[236:237], s[48:49]
    v_cvt_pk_bf16_f32 v99, v236, v237
    v_lshlrev_b32 v230, 16, v100
    v_and_b32 v231, 0xffff0000, v100
    v_pk_mul_f32 v[230:231], v[230:231], s[48:49]
    v_cvt_pk_bf16_f32 v100, v230, v231
    v_lshlrev_b32 v232, 16, v101
    v_and_b32 v233, 0xffff0000, v101
    v_pk_mul_f32 v[232:233], v[232:233], s[48:49]
    v_cvt_pk_bf16_f32 v101, v232, v233
    v_lshlrev_b32 v234, 16, v102
    v_and_b32 v235, 0xffff0000, v102
    v_pk_mul_f32 v[234:235], v[234:235], s[48:49]
    v_cvt_pk_bf16_f32 v102, v234, v235
    v_lshlrev_b32 v236, 16, v103
    v_and_b32 v237, 0xffff0000, v103
    v_pk_mul_f32 v[236:237], v[236:237], s[48:49]
    v_cvt_pk_bf16_f32 v103, v236, v237
    v_lshlrev_b32 v230, 16, v104
    v_and_b32 v231, 0xffff0000, v104
    v_pk_mul_f32 v[230:231], v[230:231], s[48:49]
    v_cvt_pk_bf16_f32 v104, v230, v231
    v_lshlrev_b32 v232, 16, v105
    v_and_b32 v233, 0xffff0000, v105
    v_pk_mul_f32 v[232:233], v[232:233], s[48:49]
    v_cvt_pk_bf16_f32 v105, v232, v233
    v_lshlrev_b32 v234, 16, v106
    v_and_b32 v235, 0xffff0000, v106
    v_pk_mul_f32 v[234:235], v[234:235], s[48:49]
    v_cvt_pk_bf16_f32 v106, v234, v235
    v_lshlrev_b32 v236, 16, v107
    v_and_b32 v237, 0xffff0000, v107
    v_pk_mul_f32 v[236:237], v[236:237], s[48:49]
    v_cvt_pk_bf16_f32 v107, v236, v237
    v_lshlrev_b32 v230, 16, v108
    v_and_b32 v231, 0xffff0000, v108
    v_pk_mul_f32 v[230:231], v[230:231], s[48:49]
    v_cvt_pk_bf16_f32 v108, v230, v231
    v_lshlrev_b32 v232, 16, v109
    v_and_b32 v233, 0xffff0000, v109
    v_pk_mul_f32 v[232:233], v[232:233], s[48:49]
    v_cvt_pk_bf16_f32 v109, v232, v233
    v_lshlrev_b32 v234, 16, v110
    v_and_b32 v235, 0xffff0000, v110
    v_pk_mul_f32 v[234:235], v[234:235], s[48:49]
    v_cvt_pk_bf16_f32 v110, v234, v235
    v_lshlrev_b32 v236, 16, v111
    v_and_b32 v237, 0xffff0000, v111
    v_pk_mul_f32 v[236:237], v[236:237], s[48:49]
    v_cvt_pk_bf16_f32 v111, v236, v237
    ds_read_b128 v[112:115], v222 offset:8192
    ds_read_b128 v[116:119], v223 offset:8192
    ds_read_b128 v[120:123], v224 offset:8192
    ds_read_b128 v[124:127], v225 offset:8192
    s_waitcnt lgkmcnt(0)
    v_lshlrev_b32 v230, 16, v112
    v_and_b32 v231, 0xffff0000, v112
    v_pk_mul_f32 v[230:231], v[230:231], s[48:49]
    v_cvt_pk_bf16_f32 v112, v230, v231
    v_lshlrev_b32 v232, 16, v113
    v_and_b32 v233, 0xffff0000, v113
    v_pk_mul_f32 v[232:233], v[232:233], s[48:49]
    v_cvt_pk_bf16_f32 v113, v232, v233
    v_lshlrev_b32 v234, 16, v114
    v_and_b32 v235, 0xffff0000, v114
    v_pk_mul_f32 v[234:235], v[234:235], s[48:49]
    v_cvt_pk_bf16_f32 v114, v234, v235
    v_lshlrev_b32 v236, 16, v115
    v_and_b32 v237, 0xffff0000, v115
    v_pk_mul_f32 v[236:237], v[236:237], s[48:49]
    v_cvt_pk_bf16_f32 v115, v236, v237
    v_lshlrev_b32 v230, 16, v116
    v_and_b32 v231, 0xffff0000, v116
    v_pk_mul_f32 v[230:231], v[230:231], s[48:49]
    v_cvt_pk_bf16_f32 v116, v230, v231
    v_lshlrev_b32 v232, 16, v117
    v_and_b32 v233, 0xffff0000, v117
    v_pk_mul_f32 v[232:233], v[232:233], s[48:49]
    v_cvt_pk_bf16_f32 v117, v232, v233
    v_lshlrev_b32 v234, 16, v118
    v_and_b32 v235, 0xffff0000, v118
    v_pk_mul_f32 v[234:235], v[234:235], s[48:49]
    v_cvt_pk_bf16_f32 v118, v234, v235
    v_lshlrev_b32 v236, 16, v119
    v_and_b32 v237, 0xffff0000, v119
    v_pk_mul_f32 v[236:237], v[236:237], s[48:49]
    v_cvt_pk_bf16_f32 v119, v236, v237
    v_lshlrev_b32 v230, 16, v120
    v_and_b32 v231, 0xffff0000, v120
    v_pk_mul_f32 v[230:231], v[230:231], s[48:49]
    v_cvt_pk_bf16_f32 v120, v230, v231
    v_lshlrev_b32 v232, 16, v121
    v_and_b32 v233, 0xffff0000, v121
    v_pk_mul_f32 v[232:233], v[232:233], s[48:49]
    v_cvt_pk_bf16_f32 v121, v232, v233
    v_lshlrev_b32 v234, 16, v122
    v_and_b32 v235, 0xffff0000, v122
    v_pk_mul_f32 v[234:235], v[234:235], s[48:49]
    v_cvt_pk_bf16_f32 v122, v234, v235
    v_lshlrev_b32 v236, 16, v123
    v_and_b32 v237, 0xffff0000, v123
    v_pk_mul_f32 v[236:237], v[236:237], s[48:49]
    v_cvt_pk_bf16_f32 v123, v236, v237
    v_lshlrev_b32 v230, 16, v124
    v_and_b32 v231, 0xffff0000, v124
    v_pk_mul_f32 v[230:231], v[230:231], s[48:49]
    v_cvt_pk_bf16_f32 v124, v230, v231
    v_lshlrev_b32 v232, 16, v125
    v_and_b32 v233, 0xffff0000, v125
    v_pk_mul_f32 v[232:233], v[232:233], s[48:49]
    v_cvt_pk_bf16_f32 v125, v232, v233
    v_lshlrev_b32 v234, 16, v126
    v_and_b32 v235, 0xffff0000, v126
    v_pk_mul_f32 v[234:235], v[234:235], s[48:49]
    v_cvt_pk_bf16_f32 v126, v234, v235
    v_lshlrev_b32 v236, 16, v127
    v_and_b32 v237, 0xffff0000, v127
    v_pk_mul_f32 v[236:237], v[236:237], s[48:49]
    v_cvt_pk_bf16_f32 v127, v236, v237
    ds_read_b128 v[128:131], v222 offset:12288
    ds_read_b128 v[132:135], v223 offset:12288
    ds_read_b128 v[136:139], v224 offset:12288
    ds_read_b128 v[140:143], v225 offset:12288
    s_waitcnt lgkmcnt(0)
    v_lshlrev_b32 v230, 16, v128
    v_and_b32 v231, 0xffff0000, v128
    v_pk_mul_f32 v[230:231], v[230:231], s[48:49]
    v_cvt_pk_bf16_f32 v128, v230, v231
    v_lshlrev_b32 v232, 16, v129
    v_and_b32 v233, 0xffff0000, v129
    v_pk_mul_f32 v[232:233], v[232:233], s[48:49]
    v_cvt_pk_bf16_f32 v129, v232, v233
    v_lshlrev_b32 v234, 16, v130
    v_and_b32 v235, 0xffff0000, v130
    v_pk_mul_f32 v[234:235], v[234:235], s[48:49]
    v_cvt_pk_bf16_f32 v130, v234, v235
    v_lshlrev_b32 v236, 16, v131
    v_and_b32 v237, 0xffff0000, v131
    v_pk_mul_f32 v[236:237], v[236:237], s[48:49]
    v_cvt_pk_bf16_f32 v131, v236, v237
    v_lshlrev_b32 v230, 16, v132
    v_and_b32 v231, 0xffff0000, v132
    v_pk_mul_f32 v[230:231], v[230:231], s[48:49]
    v_cvt_pk_bf16_f32 v132, v230, v231
    v_lshlrev_b32 v232, 16, v133
    v_and_b32 v233, 0xffff0000, v133
    v_pk_mul_f32 v[232:233], v[232:233], s[48:49]
    v_cvt_pk_bf16_f32 v133, v232, v233
    v_lshlrev_b32 v234, 16, v134
    v_and_b32 v235, 0xffff0000, v134
    v_pk_mul_f32 v[234:235], v[234:235], s[48:49]
    v_cvt_pk_bf16_f32 v134, v234, v235
    v_lshlrev_b32 v236, 16, v135
    v_and_b32 v237, 0xffff0000, v135
    v_pk_mul_f32 v[236:237], v[236:237], s[48:49]
    v_cvt_pk_bf16_f32 v135, v236, v237
    v_lshlrev_b32 v230, 16, v136
    v_and_b32 v231, 0xffff0000, v136
    v_pk_mul_f32 v[230:231], v[230:231], s[48:49]
    v_cvt_pk_bf16_f32 v136, v230, v231
    v_lshlrev_b32 v232, 16, v137
    v_and_b32 v233, 0xffff0000, v137
    v_pk_mul_f32 v[232:233], v[232:233], s[48:49]
    v_cvt_pk_bf16_f32 v137, v232, v233
    v_lshlrev_b32 v234, 16, v138
    v_and_b32 v235, 0xffff0000, v138
    v_pk_mul_f32 v[234:235], v[234:235], s[48:49]
    v_cvt_pk_bf16_f32 v138, v234, v235
    v_lshlrev_b32 v236, 16, v139
    v_and_b32 v237, 0xffff0000, v139
    v_pk_mul_f32 v[236:237], v[236:237], s[48:49]
    v_cvt_pk_bf16_f32 v139, v236, v237
    v_lshlrev_b32 v230, 16, v140
    v_and_b32 v231, 0xffff0000, v140
    v_pk_mul_f32 v[230:231], v[230:231], s[48:49]
    v_cvt_pk_bf16_f32 v140, v230, v231
    v_lshlrev_b32 v232, 16, v141
    v_and_b32 v233, 0xffff0000, v141
    v_pk_mul_f32 v[232:233], v[232:233], s[48:49]
    v_cvt_pk_bf16_f32 v141, v232, v233
    v_lshlrev_b32 v234, 16, v142
    v_and_b32 v235, 0xffff0000, v142
    v_pk_mul_f32 v[234:235], v[234:235], s[48:49]
    v_cvt_pk_bf16_f32 v142, v234, v235
    v_lshlrev_b32 v236, 16, v143
    v_and_b32 v237, 0xffff0000, v143
    v_pk_mul_f32 v[236:237], v[236:237], s[48:49]
    v_cvt_pk_bf16_f32 v143, v236, v237
    ds_read_b128 v[144:147], v222 offset:16384
    ds_read_b128 v[148:151], v223 offset:16384
    ds_read_b128 v[152:155], v224 offset:16384
    ds_read_b128 v[156:159], v225 offset:16384
    s_waitcnt lgkmcnt(0)
    v_lshlrev_b32 v230, 16, v144
    v_and_b32 v231, 0xffff0000, v144
    v_pk_mul_f32 v[230:231], v[230:231], s[48:49]
    v_cvt_pk_bf16_f32 v144, v230, v231
    v_lshlrev_b32 v232, 16, v145
    v_and_b32 v233, 0xffff0000, v145
    v_pk_mul_f32 v[232:233], v[232:233], s[48:49]
    v_cvt_pk_bf16_f32 v145, v232, v233
    v_lshlrev_b32 v234, 16, v146
    v_and_b32 v235, 0xffff0000, v146
    v_pk_mul_f32 v[234:235], v[234:235], s[48:49]
    v_cvt_pk_bf16_f32 v146, v234, v235
    v_lshlrev_b32 v236, 16, v147
    v_and_b32 v237, 0xffff0000, v147
    v_pk_mul_f32 v[236:237], v[236:237], s[48:49]
    v_cvt_pk_bf16_f32 v147, v236, v237
    v_lshlrev_b32 v230, 16, v148
    v_and_b32 v231, 0xffff0000, v148
    v_pk_mul_f32 v[230:231], v[230:231], s[48:49]
    v_cvt_pk_bf16_f32 v148, v230, v231
    v_lshlrev_b32 v232, 16, v149
    v_and_b32 v233, 0xffff0000, v149
    v_pk_mul_f32 v[232:233], v[232:233], s[48:49]
    v_cvt_pk_bf16_f32 v149, v232, v233
    v_lshlrev_b32 v234, 16, v150
    v_and_b32 v235, 0xffff0000, v150
    v_pk_mul_f32 v[234:235], v[234:235], s[48:49]
    v_cvt_pk_bf16_f32 v150, v234, v235
    v_lshlrev_b32 v236, 16, v151
    v_and_b32 v237, 0xffff0000, v151
    v_pk_mul_f32 v[236:237], v[236:237], s[48:49]
    v_cvt_pk_bf16_f32 v151, v236, v237
    v_lshlrev_b32 v230, 16, v152
    v_and_b32 v231, 0xffff0000, v152
    v_pk_mul_f32 v[230:231], v[230:231], s[48:49]
    v_cvt_pk_bf16_f32 v152, v230, v231
    v_lshlrev_b32 v232, 16, v153
    v_and_b32 v233, 0xffff0000, v153
    v_pk_mul_f32 v[232:233], v[232:233], s[48:49]
    v_cvt_pk_bf16_f32 v153, v232, v233
    v_lshlrev_b32 v234, 16, v154
    v_and_b32 v235, 0xffff0000, v154
    v_pk_mul_f32 v[234:235], v[234:235], s[48:49]
    v_cvt_pk_bf16_f32 v154, v234, v235
    v_lshlrev_b32 v236, 16, v155
    v_and_b32 v237, 0xffff0000, v155
    v_pk_mul_f32 v[236:237], v[236:237], s[48:49]
    v_cvt_pk_bf16_f32 v155, v236, v237
    v_lshlrev_b32 v230, 16, v156
    v_and_b32 v231, 0xffff0000, v156
    v_pk_mul_f32 v[230:231], v[230:231], s[48:49]
    v_cvt_pk_bf16_f32 v156, v230, v231
    v_lshlrev_b32 v232, 16, v157
    v_and_b32 v233, 0xffff0000, v157
    v_pk_mul_f32 v[232:233], v[232:233], s[48:49]
    v_cvt_pk_bf16_f32 v157, v232, v233
    v_lshlrev_b32 v234, 16, v158
    v_and_b32 v235, 0xffff0000, v158
    v_pk_mul_f32 v[234:235], v[234:235], s[48:49]
    v_cvt_pk_bf16_f32 v158, v234, v235
    v_lshlrev_b32 v236, 16, v159
    v_and_b32 v237, 0xffff0000, v159
    v_pk_mul_f32 v[236:237], v[236:237], s[48:49]
    v_cvt_pk_bf16_f32 v159, v236, v237
    v_mov_b64 v[0:1], 0
    v_mov_b64 v[2:3], 0
    v_mov_b64 v[4:5], 0
    v_mov_b64 v[6:7], 0
    v_mov_b64 v[8:9], 0
    v_mov_b64 v[10:11], 0
    v_mov_b64 v[12:13], 0
    v_mov_b64 v[14:15], 0
    v_mov_b64 v[16:17], 0
    v_mov_b64 v[18:19], 0
    v_mov_b64 v[20:21], 0
    v_mov_b64 v[22:23], 0
    v_mov_b64 v[24:25], 0
    v_mov_b64 v[26:27], 0
    v_mov_b64 v[28:29], 0
    v_mov_b64 v[30:31], 0
    v_mov_b64 v[32:33], 0
    v_mov_b64 v[34:35], 0
    v_mov_b64 v[36:37], 0
    v_mov_b64 v[38:39], 0
    v_mov_b64 v[40:41], 0
    v_mov_b64 v[42:43], 0
    v_mov_b64 v[44:45], 0
    v_mov_b64 v[46:47], 0
    v_mov_b64 v[48:49], 0
    v_mov_b64 v[50:51], 0
    v_mov_b64 v[52:53], 0
    v_mov_b64 v[54:55], 0
    v_mov_b64 v[56:57], 0
    v_mov_b64 v[58:59], 0
    v_mov_b64 v[60:61], 0
    v_mov_b64 v[62:63], 0
    v_mov_b64 v[64:65], 0
    v_mov_b64 v[66:67], 0
    v_mov_b64 v[68:69], 0
    v_mov_b64 v[70:71], 0
    v_mov_b64 v[72:73], 0
    v_mov_b64 v[74:75], 0
    v_mov_b64 v[76:77], 0
    v_mov_b64 v[78:79], 0
    v_accvgpr_write_b32 a0, 0
    v_accvgpr_write_b32 a1, 0
    v_accvgpr_write_b32 a2, 0
    v_accvgpr_write_b32 a3, 0
    v_accvgpr_write_b32 a4, 0
    v_accvgpr_write_b32 a5, 0
    v_accvgpr_write_b32 a6, 0
    v_accvgpr_write_b32 a7, 0
    v_accvgpr_write_b32 a8, 0
    v_accvgpr_write_b32 a9, 0
    v_accvgpr_write_b32 a10, 0
    v_accvgpr_write_b32 a11, 0
    v_accvgpr_write_b32 a12, 0
    v_accvgpr_write_b32 a13, 0
    v_accvgpr_write_b32 a14, 0
    v_accvgpr_write_b32 a15, 0
    v_accvgpr_write_b32 a16, 0
    v_accvgpr_write_b32 a17, 0
    v_accvgpr_write_b32 a18, 0
    v_accvgpr_write_b32 a19, 0
    v_accvgpr_write_b32 a20, 0
    v_accvgpr_write_b32 a21, 0
    v_accvgpr_write_b32 a22, 0
    v_accvgpr_write_b32 a23, 0
    v_accvgpr_write_b32 a24, 0
    v_accvgpr_write_b32 a25, 0
    v_accvgpr_write_b32 a26, 0
    v_accvgpr_write_b32 a27, 0
    v_accvgpr_write_b32 a28, 0
    v_accvgpr_write_b32 a29, 0
    v_accvgpr_write_b32 a30, 0
    v_accvgpr_write_b32 a31, 0
    v_accvgpr_write_b32 a32, 0
    v_accvgpr_write_b32 a33, 0
    v_accvgpr_write_b32 a34, 0
    v_accvgpr_write_b32 a35, 0
    v_accvgpr_write_b32 a36, 0
    v_accvgpr_write_b32 a37, 0
    v_accvgpr_write_b32 a38, 0
    v_accvgpr_write_b32 a39, 0
    v_accvgpr_write_b32 a40, 0
    v_accvgpr_write_b32 a41, 0
    v_accvgpr_write_b32 a42, 0
    v_accvgpr_write_b32 a43, 0
    v_accvgpr_write_b32 a44, 0
    v_accvgpr_write_b32 a45, 0
    v_accvgpr_write_b32 a46, 0
    v_accvgpr_write_b32 a47, 0
    v_accvgpr_write_b32 a48, 0
    v_accvgpr_write_b32 a49, 0
    v_accvgpr_write_b32 a50, 0
    v_accvgpr_write_b32 a51, 0
    v_accvgpr_write_b32 a52, 0
    v_accvgpr_write_b32 a53, 0
    v_accvgpr_write_b32 a54, 0
    v_accvgpr_write_b32 a55, 0
    v_accvgpr_write_b32 a56, 0
    v_accvgpr_write_b32 a57, 0
    v_accvgpr_write_b32 a58, 0
    v_accvgpr_write_b32 a59, 0
    v_accvgpr_write_b32 a60, 0
    v_accvgpr_write_b32 a61, 0
    v_accvgpr_write_b32 a62, 0
    v_accvgpr_write_b32 a63, 0
    v_accvgpr_write_b32 a64, 0
    v_accvgpr_write_b32 a65, 0
    v_accvgpr_write_b32 a66, 0
    v_accvgpr_write_b32 a67, 0
    v_accvgpr_write_b32 a68, 0
    v_accvgpr_write_b32 a69, 0
    v_accvgpr_write_b32 a70, 0
    v_accvgpr_write_b32 a71, 0
    v_accvgpr_write_b32 a72, 0
    v_accvgpr_write_b32 a73, 0
    v_accvgpr_write_b32 a74, 0
    v_accvgpr_write_b32 a75, 0
    v_accvgpr_write_b32 a76, 0
    v_accvgpr_write_b32 a77, 0
    v_accvgpr_write_b32 a78, 0
    v_accvgpr_write_b32 a79, 0
    v_accvgpr_write_b32 a80, 0
    v_accvgpr_write_b32 a81, 0
    v_accvgpr_write_b32 a82, 0
    v_accvgpr_write_b32 a83, 0
    v_accvgpr_write_b32 a84, 0
    v_accvgpr_write_b32 a85, 0
    v_accvgpr_write_b32 a86, 0
    v_accvgpr_write_b32 a87, 0
    v_accvgpr_write_b32 a88, 0
    v_accvgpr_write_b32 a89, 0
    v_accvgpr_write_b32 a90, 0
    v_accvgpr_write_b32 a91, 0
    v_accvgpr_write_b32 a92, 0
    v_accvgpr_write_b32 a93, 0
    v_accvgpr_write_b32 a94, 0
    v_accvgpr_write_b32 a95, 0
    v_mov_b64 v[250:251], 0
    v_accvgpr_write_b32 a96, 0
    v_accvgpr_write_b32 a97, 0
    v_accvgpr_write_b32 a98, 0
    v_accvgpr_write_b32 a99, 0
    v_mov_b32 v160, 0x7f800000
    v_mov_b32 v161, 0x7f800000
    v_mov_b32 v162, 0x7f800000
    v_mov_b32 v163, 0x7f800000
    v_mov_b32 v164, 0x7f800000
    v_mov_b32 v165, 0x7f800000
    v_mov_b32 v166, 0x7f800000
    v_mov_b32 v167, 0x7f800000
    v_mov_b32 v168, 0x7f800000
    v_mov_b32 v169, 0x7f800000
    v_mov_b32 v170, 0x7f800000
    v_mov_b32 v171, 0x7f800000
    v_mov_b32 v172, 0x7f800000
    v_mov_b32 v173, 0x7f800000
    v_mov_b32 v174, 0x7f800000
    v_mov_b32 v175, 0x7f800000
    v_mov_b32 v176, 0x7f800000
    v_mov_b32 v177, 0x7f800000
    v_mov_b32 v178, 0x7f800000
    v_mov_b32 v179, 0x7f800000
    s_lshl_b32 s28, s3, 12
    s_mov_b32 s29, s28
    s_mov_b32 s14, 524288
    s_mov_b32 s18, 524288
    s_mov_b32 s45, 32
L_slow_loop:
    s_waitcnt lgkmcnt(0)
    s_barrier
    s_mov_b32 m0, s32
    s_nop 0
    buffer_load_dwordx4 v216, s[12:15], s28 offen offset:0 nt lds
    buffer_load_dwordx4 v217, s[12:15], s28 offen offset:1024 nt lds
    buffer_load_dwordx4 v216, s[12:15], s28 offen offset:2048 nt lds
    buffer_load_dwordx4 v217, s[12:15], s28 offen offset:3072 nt lds
    s_mov_b32 m0, s36
    s_nop 0
    buffer_load_dwordx4 v216, s[16:19], s28 offen offset:0 nt lds
    buffer_load_dwordx4 v217, s[16:19], s28 offen offset:1024 nt lds
    buffer_load_dwordx4 v216, s[16:19], s28 offen offset:2048 nt lds
    buffer_load_dwordx4 v217, s[16:19], s28 offen offset:3072 nt lds
    s_add_u32 s28, s28, 16384
    s_add_u32 s29, s29, 16384
    s_waitcnt vmcnt(0)
    s_barrier
    ds_read_b128 a[100:103], v204 offset:0
    ds_read_b128 a[104:107], v205 offset:0
    ds_read_b128 a[108:111], v206 offset:0
    ds_read_b128 a[112:115], v207 offset:0
    ds_read_b128 a[116:119], v204 offset:4096
    ds_read_b128 a[120:123], v205 offset:4096
    ds_read_b128 a[124:127], v206 offset:4096
    ds_read_b128 a[128:131], v207 offset:4096
    s_waitcnt lgkmcnt(0)
    ds_read_b64_tr_b16 a[164:165], v208 offset:0
    ds_read_b64_tr_b16 a[166:167], v208 offset:4096
    ds_read_b64_tr_b16 a[168:169], v209 offset:0
    ds_read_b64_tr_b16 a[170:171], v209 offset:4096
    ds_read_b64_tr_b16 a[172:173], v210 offset:0
    ds_read_b64_tr_b16 a[174:175], v210 offset:4096
    ds_read_b64_tr_b16 a[176:177], v211 offset:0
    ds_read_b64_tr_b16 a[178:179], v211 offset:4096
    s_waitcnt lgkmcnt(0)
    ds_read_b64_tr_b16 a[180:181], v212 offset:0
    ds_read_b64_tr_b16 a[182:183], v212 offset:4096
    ds_read_b64_tr_b16 a[184:185], v213 offset:0
    ds_read_b64_tr_b16 a[186:187], v213 offset:4096
    ds_read_b64_tr_b16 a[188:189], v214 offset:0
    ds_read_b64_tr_b16 a[190:191], v214 offset:4096
    ds_read_b64_tr_b16 a[192:193], v215 offset:0
    ds_read_b64_tr_b16 a[194:195], v215 offset:4096
    s_waitcnt lgkmcnt(0)
    v_mfma_f32_16x16x32_bf16 v[180:183], a[100:103], v[80:83], 0
    v_mfma_f32_16x16x32_bf16 v[180:183], a[104:107], v[84:87], v[180:183]
    v_mfma_f32_16x16x32_bf16 v[180:183], a[108:111], v[88:91], v[180:183]
    v_mfma_f32_16x16x32_bf16 v[180:183], a[112:115], v[92:95], v[180:183]
    v_mfma_f32_16x16x32_bf16 v[184:187], a[116:119], v[80:83], 0
    v_mfma_f32_16x16x32_bf16 v[184:187], a[120:123], v[84:87], v[184:187]
    v_mfma_f32_16x16x32_bf16 v[184:187], a[124:127], v[88:91], v[184:187]
    v_mfma_f32_16x16x32_bf16 v[184:187], a[128:131], v[92:95], v[184:187]
    s_nop 7
    s_nop 1
    v_max3_f32 v218, v180, v181, v182
    v_max3_f32 v218, v218, v183, v184
    v_max3_f32 v218, v218, v185, v186
    v_max_f32 v218, v218, v187
    v_mov_b32 v219, v218
    s_nop 1
    v_permlane16_swap_b32 v218, v219
    s_nop 1
    v_max_f32 v218, v218, v219
    v_mov_b32 v219, v218
    s_nop 1
    v_permlane32_swap_b32 v218, v219
    s_nop 1
    v_max_f32 v218, v218, v219
    v_sub_f32 v218, 0, v218
    v_min_f32 v218, v218, v160
    v_sub_f32 v220, v218, v160
    v_exp_f32 v220, v220
    v_add_f32 v180, v180, v218
    v_add_f32 v181, v181, v218
    v_add_f32 v182, v182, v218
    v_add_f32 v183, v183, v218
    v_add_f32 v184, v184, v218
    v_add_f32 v185, v185, v218
    v_add_f32 v186, v186, v218
    v_add_f32 v187, v187, v218
    v_exp_f32 v180, v180
    v_exp_f32 v181, v181
    v_exp_f32 v182, v182
    v_exp_f32 v183, v183
    v_exp_f32 v184, v184
    v_exp_f32 v185, v185
    v_exp_f32 v186, v186
    v_exp_f32 v187, v187
    v_mov_b32 v160, v218
    v_mov_b32 v161, v218
    v_mov_b32 v162, v218
    v_mov_b32 v163, v218
    v_cvt_pk_bf16_f32 v196, v180, v181
    v_cvt_pk_bf16_f32 v197, v182, v183
    v_cvt_pk_bf16_f32 v198, v184, v185
    v_cvt_pk_bf16_f32 v199, v186, v187
    v_mul_f32 v0, v0, v220
    v_mul_f32 v1, v1, v220
    v_mul_f32 v2, v2, v220
    v_mul_f32 v3, v3, v220
    v_mul_f32 v4, v4, v220
    v_mul_f32 v5, v5, v220
    v_mul_f32 v6, v6, v220
    v_mul_f32 v7, v7, v220
    v_mul_f32 v8, v8, v220
    v_mul_f32 v9, v9, v220
    v_mul_f32 v10, v10, v220
    v_mul_f32 v11, v11, v220
    v_mul_f32 v12, v12, v220
    v_mul_f32 v13, v13, v220
    v_mul_f32 v14, v14, v220
    v_mul_f32 v15, v15, v220
    v_accvgpr_read_b32 v222, a0
    v_accvgpr_read_b32 v223, a1
    v_accvgpr_read_b32 v224, a2
    v_accvgpr_read_b32 v225, a3
    v_accvgpr_read_b32 v226, a4
    v_accvgpr_read_b32 v227, a5
    v_accvgpr_read_b32 v228, a6
    v_accvgpr_read_b32 v229, a7
    v_accvgpr_read_b32 v230, a8
    v_accvgpr_read_b32 v231, a9
    v_accvgpr_read_b32 v232, a10
    v_accvgpr_read_b32 v233, a11
    v_accvgpr_read_b32 v234, a12
    v_accvgpr_read_b32 v235, a13
    v_accvgpr_read_b32 v236, a14
    v_accvgpr_read_b32 v237, a15
    v_accvgpr_read_b32 v221, a80
    v_mul_f32 v222, v222, v220
    v_mul_f32 v223, v223, v220
    v_mul_f32 v224, v224, v220
    v_mul_f32 v225, v225, v220
    v_mul_f32 v226, v226, v220
    v_mul_f32 v227, v227, v220
    v_mul_f32 v228, v228, v220
    v_mul_f32 v229, v229, v220
    v_mul_f32 v230, v230, v220
    v_mul_f32 v231, v231, v220
    v_mul_f32 v232, v232, v220
    v_mul_f32 v233, v233, v220
    v_mul_f32 v234, v234, v220
    v_mul_f32 v235, v235, v220
    v_mul_f32 v236, v236, v220
    v_mul_f32 v237, v237, v220
    v_mul_f32 v221, v221, v220
    v_accvgpr_write_b32 a0, v222
    v_accvgpr_write_b32 a1, v223
    v_accvgpr_write_b32 a2, v224
    v_accvgpr_write_b32 a3, v225
    v_accvgpr_write_b32 a4, v226
    v_accvgpr_write_b32 a5, v227
    v_accvgpr_write_b32 a6, v228
    v_accvgpr_write_b32 a7, v229
    v_accvgpr_write_b32 a8, v230
    v_accvgpr_write_b32 a9, v231
    v_accvgpr_write_b32 a10, v232
    v_accvgpr_write_b32 a11, v233
    v_accvgpr_write_b32 a12, v234
    v_accvgpr_write_b32 a13, v235
    v_accvgpr_write_b32 a14, v236
    v_accvgpr_write_b32 a15, v237
    v_accvgpr_write_b32 a80, v221
    s_nop 1
    v_mfma_f32_16x16x32_bf16 v[0:3], a[164:167], v[196:199], v[0:3]
    v_mfma_f32_16x16x32_bf16 v[4:7], a[168:171], v[196:199], v[4:7]
    v_mfma_f32_16x16x32_bf16 v[8:11], a[172:175], v[196:199], v[8:11]
    v_mfma_f32_16x16x32_bf16 v[12:15], a[176:179], v[196:199], v[12:15]
    v_mfma_f32_16x16x32_bf16 a[0:3], a[180:183], v[196:199], a[0:3]
    v_mfma_f32_16x16x32_bf16 a[4:7], a[184:187], v[196:199], a[4:7]
    v_mfma_f32_16x16x32_bf16 a[8:11], a[188:191], v[196:199], a[8:11]
    v_mfma_f32_16x16x32_bf16 a[12:15], a[192:195], v[196:199], a[12:15]
    v_mfma_f32_16x16x32_bf16 a[80:83], a[228:231], v[196:199], a[80:83]
    v_mfma_f32_16x16x32_bf16 v[180:183], a[100:103], v[96:99], 0
    v_mfma_f32_16x16x32_bf16 v[180:183], a[104:107], v[100:103], v[180:183]
    v_mfma_f32_16x16x32_bf16 v[180:183], a[108:111], v[104:107], v[180:183]
    v_mfma_f32_16x16x32_bf16 v[180:183], a[112:115], v[108:111], v[180:183]
    v_mfma_f32_16x16x32_bf16 v[184:187], a[116:119], v[96:99], 0
    v_mfma_f32_16x16x32_bf16 v[184:187], a[120:123], v[100:103], v[184:187]
    v_mfma_f32_16x16x32_bf16 v[184:187], a[124:127], v[104:107], v[184:187]
    v_mfma_f32_16x16x32_bf16 v[184:187], a[128:131], v[108:111], v[184:187]
    s_nop 7
    s_nop 1
    v_max3_f32 v218, v180, v181, v182
    v_max3_f32 v218, v218, v183, v184
    v_max3_f32 v218, v218, v185, v186
    v_max_f32 v218, v218, v187
    v_mov_b32 v219, v218
    s_nop 1
    v_permlane16_swap_b32 v218, v219
    s_nop 1
    v_max_f32 v218, v218, v219
    v_mov_b32 v219, v218
    s_nop 1
    v_permlane32_swap_b32 v218, v219
    s_nop 1
    v_max_f32 v218, v218, v219
    v_sub_f32 v218, 0, v218
    v_min_f32 v218, v218, v164
    v_sub_f32 v220, v218, v164
    v_exp_f32 v220, v220
    v_add_f32 v180, v180, v218
    v_add_f32 v181, v181, v218
    v_add_f32 v182, v182, v218
    v_add_f32 v183, v183, v218
    v_add_f32 v184, v184, v218
    v_add_f32 v185, v185, v218
    v_add_f32 v186, v186, v218
    v_add_f32 v187, v187, v218
    v_exp_f32 v180, v180
    v_exp_f32 v181, v181
    v_exp_f32 v182, v182
    v_exp_f32 v183, v183
    v_exp_f32 v184, v184
    v_exp_f32 v185, v185
    v_exp_f32 v186, v186
    v_exp_f32 v187, v187
    v_mov_b32 v164, v218
    v_mov_b32 v165, v218
    v_mov_b32 v166, v218
    v_mov_b32 v167, v218
    v_cvt_pk_bf16_f32 v196, v180, v181
    v_cvt_pk_bf16_f32 v197, v182, v183
    v_cvt_pk_bf16_f32 v198, v184, v185
    v_cvt_pk_bf16_f32 v199, v186, v187
    v_mul_f32 v16, v16, v220
    v_mul_f32 v17, v17, v220
    v_mul_f32 v18, v18, v220
    v_mul_f32 v19, v19, v220
    v_mul_f32 v20, v20, v220
    v_mul_f32 v21, v21, v220
    v_mul_f32 v22, v22, v220
    v_mul_f32 v23, v23, v220
    v_mul_f32 v24, v24, v220
    v_mul_f32 v25, v25, v220
    v_mul_f32 v26, v26, v220
    v_mul_f32 v27, v27, v220
    v_mul_f32 v28, v28, v220
    v_mul_f32 v29, v29, v220
    v_mul_f32 v30, v30, v220
    v_mul_f32 v31, v31, v220
    v_accvgpr_read_b32 v222, a16
    v_accvgpr_read_b32 v223, a17
    v_accvgpr_read_b32 v224, a18
    v_accvgpr_read_b32 v225, a19
    v_accvgpr_read_b32 v226, a20
    v_accvgpr_read_b32 v227, a21
    v_accvgpr_read_b32 v228, a22
    v_accvgpr_read_b32 v229, a23
    v_accvgpr_read_b32 v230, a24
    v_accvgpr_read_b32 v231, a25
    v_accvgpr_read_b32 v232, a26
    v_accvgpr_read_b32 v233, a27
    v_accvgpr_read_b32 v234, a28
    v_accvgpr_read_b32 v235, a29
    v_accvgpr_read_b32 v236, a30
    v_accvgpr_read_b32 v237, a31
    v_accvgpr_read_b32 v221, a84
    v_mul_f32 v222, v222, v220
    v_mul_f32 v223, v223, v220
    v_mul_f32 v224, v224, v220
    v_mul_f32 v225, v225, v220
    v_mul_f32 v226, v226, v220
    v_mul_f32 v227, v227, v220
    v_mul_f32 v228, v228, v220
    v_mul_f32 v229, v229, v220
    v_mul_f32 v230, v230, v220
    v_mul_f32 v231, v231, v220
    v_mul_f32 v232, v232, v220
    v_mul_f32 v233, v233, v220
    v_mul_f32 v234, v234, v220
    v_mul_f32 v235, v235, v220
    v_mul_f32 v236, v236, v220
    v_mul_f32 v237, v237, v220
    v_mul_f32 v221, v221, v220
    v_accvgpr_write_b32 a16, v222
    v_accvgpr_write_b32 a17, v223
    v_accvgpr_write_b32 a18, v224
    v_accvgpr_write_b32 a19, v225
    v_accvgpr_write_b32 a20, v226
    v_accvgpr_write_b32 a21, v227
    v_accvgpr_write_b32 a22, v228
    v_accvgpr_write_b32 a23, v229
    v_accvgpr_write_b32 a24, v230
    v_accvgpr_write_b32 a25, v231
    v_accvgpr_write_b32 a26, v232
    v_accvgpr_write_b32 a27, v233
    v_accvgpr_write_b32 a28, v234
    v_accvgpr_write_b32 a29, v235
    v_accvgpr_write_b32 a30, v236
    v_accvgpr_write_b32 a31, v237
    v_accvgpr_write_b32 a84, v221
    s_nop 1
    v_mfma_f32_16x16x32_bf16 v[16:19], a[164:167], v[196:199], v[16:19]
    v_mfma_f32_16x16x32_bf16 v[20:23], a[168:171], v[196:199], v[20:23]
    v_mfma_f32_16x16x32_bf16 v[24:27], a[172:175], v[196:199], v[24:27]
    v_mfma_f32_16x16x32_bf16 v[28:31], a[176:179], v[196:199], v[28:31]
    v_mfma_f32_16x16x32_bf16 a[16:19], a[180:183], v[196:199], a[16:19]
    v_mfma_f32_16x16x32_bf16 a[20:23], a[184:187], v[196:199], a[20:23]
    v_mfma_f32_16x16x32_bf16 a[24:27], a[188:191], v[196:199], a[24:27]
    v_mfma_f32_16x16x32_bf16 a[28:31], a[192:195], v[196:199], a[28:31]
    v_mfma_f32_16x16x32_bf16 a[84:87], a[228:231], v[196:199], a[84:87]
    v_mfma_f32_16x16x32_bf16 v[180:183], a[100:103], v[112:115], 0
    v_mfma_f32_16x16x32_bf16 v[180:183], a[104:107], v[116:119], v[180:183]
    v_mfma_f32_16x16x32_bf16 v[180:183], a[108:111], v[120:123], v[180:183]
    v_mfma_f32_16x16x32_bf16 v[180:183], a[112:115], v[124:127], v[180:183]
    v_mfma_f32_16x16x32_bf16 v[184:187], a[116:119], v[112:115], 0
    v_mfma_f32_16x16x32_bf16 v[184:187], a[120:123], v[116:119], v[184:187]
    v_mfma_f32_16x16x32_bf16 v[184:187], a[124:127], v[120:123], v[184:187]
    v_mfma_f32_16x16x32_bf16 v[184:187], a[128:131], v[124:127], v[184:187]
    s_nop 7
    s_nop 1
    v_max3_f32 v218, v180, v181, v182
    v_max3_f32 v218, v218, v183, v184
    v_max3_f32 v218, v218, v185, v186
    v_max_f32 v218, v218, v187
    v_mov_b32 v219, v218
    s_nop 1
    v_permlane16_swap_b32 v218, v219
    s_nop 1
    v_max_f32 v218, v218, v219
    v_mov_b32 v219, v218
    s_nop 1
    v_permlane32_swap_b32 v218, v219
    s_nop 1
    v_max_f32 v218, v218, v219
    v_sub_f32 v218, 0, v218
    v_min_f32 v218, v218, v168
    v_sub_f32 v220, v218, v168
    v_exp_f32 v220, v220
    v_add_f32 v180, v180, v218
    v_add_f32 v181, v181, v218
    v_add_f32 v182, v182, v218
    v_add_f32 v183, v183, v218
    v_add_f32 v184, v184, v218
    v_add_f32 v185, v185, v218
    v_add_f32 v186, v186, v218
    v_add_f32 v187, v187, v218
    v_exp_f32 v180, v180
    v_exp_f32 v181, v181
    v_exp_f32 v182, v182
    v_exp_f32 v183, v183
    v_exp_f32 v184, v184
    v_exp_f32 v185, v185
    v_exp_f32 v186, v186
    v_exp_f32 v187, v187
    v_mov_b32 v168, v218
    v_mov_b32 v169, v218
    v_mov_b32 v170, v218
    v_mov_b32 v171, v218
    v_cvt_pk_bf16_f32 v196, v180, v181
    v_cvt_pk_bf16_f32 v197, v182, v183
    v_cvt_pk_bf16_f32 v198, v184, v185
    v_cvt_pk_bf16_f32 v199, v186, v187
    v_mul_f32 v32, v32, v220
    v_mul_f32 v33, v33, v220
    v_mul_f32 v34, v34, v220
    v_mul_f32 v35, v35, v220
    v_mul_f32 v36, v36, v220
    v_mul_f32 v37, v37, v220
    v_mul_f32 v38, v38, v220
    v_mul_f32 v39, v39, v220
    v_mul_f32 v40, v40, v220
    v_mul_f32 v41, v41, v220
    v_mul_f32 v42, v42, v220
    v_mul_f32 v43, v43, v220
    v_mul_f32 v44, v44, v220
    v_mul_f32 v45, v45, v220
    v_mul_f32 v46, v46, v220
    v_mul_f32 v47, v47, v220
    v_accvgpr_read_b32 v222, a32
    v_accvgpr_read_b32 v223, a33
    v_accvgpr_read_b32 v224, a34
    v_accvgpr_read_b32 v225, a35
    v_accvgpr_read_b32 v226, a36
    v_accvgpr_read_b32 v227, a37
    v_accvgpr_read_b32 v228, a38
    v_accvgpr_read_b32 v229, a39
    v_accvgpr_read_b32 v230, a40
    v_accvgpr_read_b32 v231, a41
    v_accvgpr_read_b32 v232, a42
    v_accvgpr_read_b32 v233, a43
    v_accvgpr_read_b32 v234, a44
    v_accvgpr_read_b32 v235, a45
    v_accvgpr_read_b32 v236, a46
    v_accvgpr_read_b32 v237, a47
    v_accvgpr_read_b32 v221, a88
    v_mul_f32 v222, v222, v220
    v_mul_f32 v223, v223, v220
    v_mul_f32 v224, v224, v220
    v_mul_f32 v225, v225, v220
    v_mul_f32 v226, v226, v220
    v_mul_f32 v227, v227, v220
    v_mul_f32 v228, v228, v220
    v_mul_f32 v229, v229, v220
    v_mul_f32 v230, v230, v220
    v_mul_f32 v231, v231, v220
    v_mul_f32 v232, v232, v220
    v_mul_f32 v233, v233, v220
    v_mul_f32 v234, v234, v220
    v_mul_f32 v235, v235, v220
    v_mul_f32 v236, v236, v220
    v_mul_f32 v237, v237, v220
    v_mul_f32 v221, v221, v220
    v_accvgpr_write_b32 a32, v222
    v_accvgpr_write_b32 a33, v223
    v_accvgpr_write_b32 a34, v224
    v_accvgpr_write_b32 a35, v225
    v_accvgpr_write_b32 a36, v226
    v_accvgpr_write_b32 a37, v227
    v_accvgpr_write_b32 a38, v228
    v_accvgpr_write_b32 a39, v229
    v_accvgpr_write_b32 a40, v230
    v_accvgpr_write_b32 a41, v231
    v_accvgpr_write_b32 a42, v232
    v_accvgpr_write_b32 a43, v233
    v_accvgpr_write_b32 a44, v234
    v_accvgpr_write_b32 a45, v235
    v_accvgpr_write_b32 a46, v236
    v_accvgpr_write_b32 a47, v237
    v_accvgpr_write_b32 a88, v221
    s_nop 1
    v_mfma_f32_16x16x32_bf16 v[32:35], a[164:167], v[196:199], v[32:35]
    v_mfma_f32_16x16x32_bf16 v[36:39], a[168:171], v[196:199], v[36:39]
    v_mfma_f32_16x16x32_bf16 v[40:43], a[172:175], v[196:199], v[40:43]
    v_mfma_f32_16x16x32_bf16 v[44:47], a[176:179], v[196:199], v[44:47]
    v_mfma_f32_16x16x32_bf16 a[32:35], a[180:183], v[196:199], a[32:35]
    v_mfma_f32_16x16x32_bf16 a[36:39], a[184:187], v[196:199], a[36:39]
    v_mfma_f32_16x16x32_bf16 a[40:43], a[188:191], v[196:199], a[40:43]
    v_mfma_f32_16x16x32_bf16 a[44:47], a[192:195], v[196:199], a[44:47]
    v_mfma_f32_16x16x32_bf16 a[88:91], a[228:231], v[196:199], a[88:91]
    v_mfma_f32_16x16x32_bf16 v[180:183], a[100:103], v[128:131], 0
    v_mfma_f32_16x16x32_bf16 v[180:183], a[104:107], v[132:135], v[180:183]
    v_mfma_f32_16x16x32_bf16 v[180:183], a[108:111], v[136:139], v[180:183]
    v_mfma_f32_16x16x32_bf16 v[180:183], a[112:115], v[140:143], v[180:183]
    v_mfma_f32_16x16x32_bf16 v[184:187], a[116:119], v[128:131], 0
    v_mfma_f32_16x16x32_bf16 v[184:187], a[120:123], v[132:135], v[184:187]
    v_mfma_f32_16x16x32_bf16 v[184:187], a[124:127], v[136:139], v[184:187]
    v_mfma_f32_16x16x32_bf16 v[184:187], a[128:131], v[140:143], v[184:187]
    s_nop 7
    s_nop 1
    v_max3_f32 v218, v180, v181, v182
    v_max3_f32 v218, v218, v183, v184
    v_max3_f32 v218, v218, v185, v186
    v_max_f32 v218, v218, v187
    v_mov_b32 v219, v218
    s_nop 1
    v_permlane16_swap_b32 v218, v219
    s_nop 1
    v_max_f32 v218, v218, v219
    v_mov_b32 v219, v218
    s_nop 1
    v_permlane32_swap_b32 v218, v219
    s_nop 1
    v_max_f32 v218, v218, v219
    v_sub_f32 v218, 0, v218
    v_min_f32 v218, v218, v172
    v_sub_f32 v220, v218, v172
    v_exp_f32 v220, v220
    v_add_f32 v180, v180, v218
    v_add_f32 v181, v181, v218
    v_add_f32 v182, v182, v218
    v_add_f32 v183, v183, v218
    v_add_f32 v184, v184, v218
    v_add_f32 v185, v185, v218
    v_add_f32 v186, v186, v218
    v_add_f32 v187, v187, v218
    v_exp_f32 v180, v180
    v_exp_f32 v181, v181
    v_exp_f32 v182, v182
    v_exp_f32 v183, v183
    v_exp_f32 v184, v184
    v_exp_f32 v185, v185
    v_exp_f32 v186, v186
    v_exp_f32 v187, v187
    v_mov_b32 v172, v218
    v_mov_b32 v173, v218
    v_mov_b32 v174, v218
    v_mov_b32 v175, v218
    v_cvt_pk_bf16_f32 v196, v180, v181
    v_cvt_pk_bf16_f32 v197, v182, v183
    v_cvt_pk_bf16_f32 v198, v184, v185
    v_cvt_pk_bf16_f32 v199, v186, v187
    v_mul_f32 v48, v48, v220
    v_mul_f32 v49, v49, v220
    v_mul_f32 v50, v50, v220
    v_mul_f32 v51, v51, v220
    v_mul_f32 v52, v52, v220
    v_mul_f32 v53, v53, v220
    v_mul_f32 v54, v54, v220
    v_mul_f32 v55, v55, v220
    v_mul_f32 v56, v56, v220
    v_mul_f32 v57, v57, v220
    v_mul_f32 v58, v58, v220
    v_mul_f32 v59, v59, v220
    v_mul_f32 v60, v60, v220
    v_mul_f32 v61, v61, v220
    v_mul_f32 v62, v62, v220
    v_mul_f32 v63, v63, v220
    v_accvgpr_read_b32 v222, a48
    v_accvgpr_read_b32 v223, a49
    v_accvgpr_read_b32 v224, a50
    v_accvgpr_read_b32 v225, a51
    v_accvgpr_read_b32 v226, a52
    v_accvgpr_read_b32 v227, a53
    v_accvgpr_read_b32 v228, a54
    v_accvgpr_read_b32 v229, a55
    v_accvgpr_read_b32 v230, a56
    v_accvgpr_read_b32 v231, a57
    v_accvgpr_read_b32 v232, a58
    v_accvgpr_read_b32 v233, a59
    v_accvgpr_read_b32 v234, a60
    v_accvgpr_read_b32 v235, a61
    v_accvgpr_read_b32 v236, a62
    v_accvgpr_read_b32 v237, a63
    v_accvgpr_read_b32 v221, a92
    v_mul_f32 v222, v222, v220
    v_mul_f32 v223, v223, v220
    v_mul_f32 v224, v224, v220
    v_mul_f32 v225, v225, v220
    v_mul_f32 v226, v226, v220
    v_mul_f32 v227, v227, v220
    v_mul_f32 v228, v228, v220
    v_mul_f32 v229, v229, v220
    v_mul_f32 v230, v230, v220
    v_mul_f32 v231, v231, v220
    v_mul_f32 v232, v232, v220
    v_mul_f32 v233, v233, v220
    v_mul_f32 v234, v234, v220
    v_mul_f32 v235, v235, v220
    v_mul_f32 v236, v236, v220
    v_mul_f32 v237, v237, v220
    v_mul_f32 v221, v221, v220
    v_accvgpr_write_b32 a48, v222
    v_accvgpr_write_b32 a49, v223
    v_accvgpr_write_b32 a50, v224
    v_accvgpr_write_b32 a51, v225
    v_accvgpr_write_b32 a52, v226
    v_accvgpr_write_b32 a53, v227
    v_accvgpr_write_b32 a54, v228
    v_accvgpr_write_b32 a55, v229
    v_accvgpr_write_b32 a56, v230
    v_accvgpr_write_b32 a57, v231
    v_accvgpr_write_b32 a58, v232
    v_accvgpr_write_b32 a59, v233
    v_accvgpr_write_b32 a60, v234
    v_accvgpr_write_b32 a61, v235
    v_accvgpr_write_b32 a62, v236
    v_accvgpr_write_b32 a63, v237
    v_accvgpr_write_b32 a92, v221
    s_nop 1
    v_mfma_f32_16x16x32_bf16 v[48:51], a[164:167], v[196:199], v[48:51]
    v_mfma_f32_16x16x32_bf16 v[52:55], a[168:171], v[196:199], v[52:55]
    v_mfma_f32_16x16x32_bf16 v[56:59], a[172:175], v[196:199], v[56:59]
    v_mfma_f32_16x16x32_bf16 v[60:63], a[176:179], v[196:199], v[60:63]
    v_mfma_f32_16x16x32_bf16 a[48:51], a[180:183], v[196:199], a[48:51]
    v_mfma_f32_16x16x32_bf16 a[52:55], a[184:187], v[196:199], a[52:55]
    v_mfma_f32_16x16x32_bf16 a[56:59], a[188:191], v[196:199], a[56:59]
    v_mfma_f32_16x16x32_bf16 a[60:63], a[192:195], v[196:199], a[60:63]
    v_mfma_f32_16x16x32_bf16 a[92:95], a[228:231], v[196:199], a[92:95]
    v_mfma_f32_16x16x32_bf16 v[180:183], a[100:103], v[144:147], 0
    v_mfma_f32_16x16x32_bf16 v[180:183], a[104:107], v[148:151], v[180:183]
    v_mfma_f32_16x16x32_bf16 v[180:183], a[108:111], v[152:155], v[180:183]
    v_mfma_f32_16x16x32_bf16 v[180:183], a[112:115], v[156:159], v[180:183]
    v_mfma_f32_16x16x32_bf16 v[184:187], a[116:119], v[144:147], 0
    v_mfma_f32_16x16x32_bf16 v[184:187], a[120:123], v[148:151], v[184:187]
    v_mfma_f32_16x16x32_bf16 v[184:187], a[124:127], v[152:155], v[184:187]
    v_mfma_f32_16x16x32_bf16 v[184:187], a[128:131], v[156:159], v[184:187]
    s_nop 7
    s_nop 1
    v_max3_f32 v218, v180, v181, v182
    v_max3_f32 v218, v218, v183, v184
    v_max3_f32 v218, v218, v185, v186
    v_max_f32 v218, v218, v187
    v_mov_b32 v219, v218
    s_nop 1
    v_permlane16_swap_b32 v218, v219
    s_nop 1
    v_max_f32 v218, v218, v219
    v_mov_b32 v219, v218
    s_nop 1
    v_permlane32_swap_b32 v218, v219
    s_nop 1
    v_max_f32 v218, v218, v219
    v_sub_f32 v218, 0, v218
    v_min_f32 v218, v218, v176
    v_sub_f32 v220, v218, v176
    v_exp_f32 v220, v220
    v_add_f32 v180, v180, v218
    v_add_f32 v181, v181, v218
    v_add_f32 v182, v182, v218
    v_add_f32 v183, v183, v218
    v_add_f32 v184, v184, v218
    v_add_f32 v185, v185, v218
    v_add_f32 v186, v186, v218
    v_add_f32 v187, v187, v218
    v_exp_f32 v180, v180
    v_exp_f32 v181, v181
    v_exp_f32 v182, v182
    v_exp_f32 v183, v183
    v_exp_f32 v184, v184
    v_exp_f32 v185, v185
    v_exp_f32 v186, v186
    v_exp_f32 v187, v187
    v_mov_b32 v176, v218
    v_mov_b32 v177, v218
    v_mov_b32 v178, v218
    v_mov_b32 v179, v218
    v_cvt_pk_bf16_f32 v196, v180, v181
    v_cvt_pk_bf16_f32 v197, v182, v183
    v_cvt_pk_bf16_f32 v198, v184, v185
    v_cvt_pk_bf16_f32 v199, v186, v187
    v_mul_f32 v64, v64, v220
    v_mul_f32 v65, v65, v220
    v_mul_f32 v66, v66, v220
    v_mul_f32 v67, v67, v220
    v_mul_f32 v68, v68, v220
    v_mul_f32 v69, v69, v220
    v_mul_f32 v70, v70, v220
    v_mul_f32 v71, v71, v220
    v_mul_f32 v72, v72, v220
    v_mul_f32 v73, v73, v220
    v_mul_f32 v74, v74, v220
    v_mul_f32 v75, v75, v220
    v_mul_f32 v76, v76, v220
    v_mul_f32 v77, v77, v220
    v_mul_f32 v78, v78, v220
    v_mul_f32 v79, v79, v220
    v_accvgpr_read_b32 v222, a64
    v_accvgpr_read_b32 v223, a65
    v_accvgpr_read_b32 v224, a66
    v_accvgpr_read_b32 v225, a67
    v_accvgpr_read_b32 v226, a68
    v_accvgpr_read_b32 v227, a69
    v_accvgpr_read_b32 v228, a70
    v_accvgpr_read_b32 v229, a71
    v_accvgpr_read_b32 v230, a72
    v_accvgpr_read_b32 v231, a73
    v_accvgpr_read_b32 v232, a74
    v_accvgpr_read_b32 v233, a75
    v_accvgpr_read_b32 v234, a76
    v_accvgpr_read_b32 v235, a77
    v_accvgpr_read_b32 v236, a78
    v_accvgpr_read_b32 v237, a79
    v_accvgpr_read_b32 v221, a96
    v_mul_f32 v222, v222, v220
    v_mul_f32 v223, v223, v220
    v_mul_f32 v224, v224, v220
    v_mul_f32 v225, v225, v220
    v_mul_f32 v226, v226, v220
    v_mul_f32 v227, v227, v220
    v_mul_f32 v228, v228, v220
    v_mul_f32 v229, v229, v220
    v_mul_f32 v230, v230, v220
    v_mul_f32 v231, v231, v220
    v_mul_f32 v232, v232, v220
    v_mul_f32 v233, v233, v220
    v_mul_f32 v234, v234, v220
    v_mul_f32 v235, v235, v220
    v_mul_f32 v236, v236, v220
    v_mul_f32 v237, v237, v220
    v_mul_f32 v221, v221, v220
    v_accvgpr_write_b32 a64, v222
    v_accvgpr_write_b32 a65, v223
    v_accvgpr_write_b32 a66, v224
    v_accvgpr_write_b32 a67, v225
    v_accvgpr_write_b32 a68, v226
    v_accvgpr_write_b32 a69, v227
    v_accvgpr_write_b32 a70, v228
    v_accvgpr_write_b32 a71, v229
    v_accvgpr_write_b32 a72, v230
    v_accvgpr_write_b32 a73, v231
    v_accvgpr_write_b32 a74, v232
    v_accvgpr_write_b32 a75, v233
    v_accvgpr_write_b32 a76, v234
    v_accvgpr_write_b32 a77, v235
    v_accvgpr_write_b32 a78, v236
    v_accvgpr_write_b32 a79, v237
    v_accvgpr_write_b32 a96, v221
    s_nop 1
    v_mfma_f32_16x16x32_bf16 v[64:67], a[164:167], v[196:199], v[64:67]
    v_mfma_f32_16x16x32_bf16 v[68:71], a[168:171], v[196:199], v[68:71]
    v_mfma_f32_16x16x32_bf16 v[72:75], a[172:175], v[196:199], v[72:75]
    v_mfma_f32_16x16x32_bf16 v[76:79], a[176:179], v[196:199], v[76:79]
    v_mfma_f32_16x16x32_bf16 a[64:67], a[180:183], v[196:199], a[64:67]
    v_mfma_f32_16x16x32_bf16 a[68:71], a[184:187], v[196:199], a[68:71]
    v_mfma_f32_16x16x32_bf16 a[72:75], a[188:191], v[196:199], a[72:75]
    v_mfma_f32_16x16x32_bf16 a[76:79], a[192:195], v[196:199], a[76:79]
    v_mfma_f32_16x16x32_bf16 a[96:99], a[228:231], v[196:199], a[96:99]
    s_sub_u32 s45, s45, 1
    s_cmp_lg_u32 s45, 0
    s_cbranch_scc1 L_slow_loop
    s_nop 7
    s_waitcnt lgkmcnt(0)
    s_barrier
    s_mul_i32 s55, s3, 1280
    s_add_u32 s55, s55, 40960
    v_lshlrev_b32 v218, 2, v252
    v_add_u32 v218, s55, v218
    ds_write_b32 v218, v160 offset:0
    ds_write_b32 v218, v164 offset:256
    ds_write_b32 v218, v168 offset:512
    ds_write_b32 v218, v172 offset:768
    ds_write_b32 v218, v176 offset:1024
    s_waitcnt lgkmcnt(0)
    s_barrier
    s_xor_b32 s55, s3, 1
    s_mul_i32 s56, s55, 1280
    s_add_u32 s56, s56, 40960
    v_lshlrev_b32 v218, 2, v252
    v_add_u32 v218, s56, v218
    ds_read_b32 v180, v218 offset:0
    ds_read_b32 v181, v218 offset:256
    ds_read_b32 v182, v218 offset:512
    ds_read_b32 v183, v218 offset:768
    ds_read_b32 v184, v218 offset:1024
    s_waitcnt lgkmcnt(0)
    s_barrier
    v_min_f32 v188, v160, v180
    v_sub_f32 v188, v188, v160
    v_exp_f32 v188, v188
    s_nop 0
    v_mul_f32 v0, v0, v188
    v_mul_f32 v1, v1, v188
    v_mul_f32 v2, v2, v188
    v_mul_f32 v3, v3, v188
    v_mul_f32 v4, v4, v188
    v_mul_f32 v5, v5, v188
    v_mul_f32 v6, v6, v188
    v_mul_f32 v7, v7, v188
    v_mul_f32 v8, v8, v188
    v_mul_f32 v9, v9, v188
    v_mul_f32 v10, v10, v188
    v_mul_f32 v11, v11, v188
    v_mul_f32 v12, v12, v188
    v_mul_f32 v13, v13, v188
    v_mul_f32 v14, v14, v188
    v_mul_f32 v15, v15, v188
    v_accvgpr_read_b32 v222, a0
    v_accvgpr_read_b32 v223, a1
    v_accvgpr_read_b32 v224, a2
    v_accvgpr_read_b32 v225, a3
    v_accvgpr_read_b32 v226, a4
    v_accvgpr_read_b32 v227, a5
    v_accvgpr_read_b32 v228, a6
    v_accvgpr_read_b32 v229, a7
    v_accvgpr_read_b32 v230, a8
    v_accvgpr_read_b32 v231, a9
    v_accvgpr_read_b32 v232, a10
    v_accvgpr_read_b32 v233, a11
    v_accvgpr_read_b32 v234, a12
    v_accvgpr_read_b32 v235, a13
    v_accvgpr_read_b32 v236, a14
    v_accvgpr_read_b32 v237, a15
    v_accvgpr_read_b32 v221, a80
    v_mul_f32 v222, v222, v188
    v_mul_f32 v223, v223, v188
    v_mul_f32 v224, v224, v188
    v_mul_f32 v225, v225, v188
    v_mul_f32 v226, v226, v188
    v_mul_f32 v227, v227, v188
    v_mul_f32 v228, v228, v188
    v_mul_f32 v229, v229, v188
    v_mul_f32 v230, v230, v188
    v_mul_f32 v231, v231, v188
    v_mul_f32 v232, v232, v188
    v_mul_f32 v233, v233, v188
    v_mul_f32 v234, v234, v188
    v_mul_f32 v235, v235, v188
    v_mul_f32 v236, v236, v188
    v_mul_f32 v237, v237, v188
    v_mul_f32 v221, v221, v188
    v_accvgpr_write_b32 a0, v222
    v_accvgpr_write_b32 a1, v223
    v_accvgpr_write_b32 a2, v224
    v_accvgpr_write_b32 a3, v225
    v_accvgpr_write_b32 a4, v226
    v_accvgpr_write_b32 a5, v227
    v_accvgpr_write_b32 a6, v228
    v_accvgpr_write_b32 a7, v229
    v_accvgpr_write_b32 a8, v230
    v_accvgpr_write_b32 a9, v231
    v_accvgpr_write_b32 a10, v232
    v_accvgpr_write_b32 a11, v233
    v_accvgpr_write_b32 a12, v234
    v_accvgpr_write_b32 a13, v235
    v_accvgpr_write_b32 a14, v236
    v_accvgpr_write_b32 a15, v237
    v_accvgpr_write_b32 a80, v221
    v_min_f32 v188, v164, v181
    v_sub_f32 v188, v188, v164
    v_exp_f32 v188, v188
    s_nop 0
    v_mul_f32 v16, v16, v188
    v_mul_f32 v17, v17, v188
    v_mul_f32 v18, v18, v188
    v_mul_f32 v19, v19, v188
    v_mul_f32 v20, v20, v188
    v_mul_f32 v21, v21, v188
    v_mul_f32 v22, v22, v188
    v_mul_f32 v23, v23, v188
    v_mul_f32 v24, v24, v188
    v_mul_f32 v25, v25, v188
    v_mul_f32 v26, v26, v188
    v_mul_f32 v27, v27, v188
    v_mul_f32 v28, v28, v188
    v_mul_f32 v29, v29, v188
    v_mul_f32 v30, v30, v188
    v_mul_f32 v31, v31, v188
    v_accvgpr_read_b32 v222, a16
    v_accvgpr_read_b32 v223, a17
    v_accvgpr_read_b32 v224, a18
    v_accvgpr_read_b32 v225, a19
    v_accvgpr_read_b32 v226, a20
    v_accvgpr_read_b32 v227, a21
    v_accvgpr_read_b32 v228, a22
    v_accvgpr_read_b32 v229, a23
    v_accvgpr_read_b32 v230, a24
    v_accvgpr_read_b32 v231, a25
    v_accvgpr_read_b32 v232, a26
    v_accvgpr_read_b32 v233, a27
    v_accvgpr_read_b32 v234, a28
    v_accvgpr_read_b32 v235, a29
    v_accvgpr_read_b32 v236, a30
    v_accvgpr_read_b32 v237, a31
    v_accvgpr_read_b32 v221, a84
    v_mul_f32 v222, v222, v188
    v_mul_f32 v223, v223, v188
    v_mul_f32 v224, v224, v188
    v_mul_f32 v225, v225, v188
    v_mul_f32 v226, v226, v188
    v_mul_f32 v227, v227, v188
    v_mul_f32 v228, v228, v188
    v_mul_f32 v229, v229, v188
    v_mul_f32 v230, v230, v188
    v_mul_f32 v231, v231, v188
    v_mul_f32 v232, v232, v188
    v_mul_f32 v233, v233, v188
    v_mul_f32 v234, v234, v188
    v_mul_f32 v235, v235, v188
    v_mul_f32 v236, v236, v188
    v_mul_f32 v237, v237, v188
    v_mul_f32 v221, v221, v188
    v_accvgpr_write_b32 a16, v222
    v_accvgpr_write_b32 a17, v223
    v_accvgpr_write_b32 a18, v224
    v_accvgpr_write_b32 a19, v225
    v_accvgpr_write_b32 a20, v226
    v_accvgpr_write_b32 a21, v227
    v_accvgpr_write_b32 a22, v228
    v_accvgpr_write_b32 a23, v229
    v_accvgpr_write_b32 a24, v230
    v_accvgpr_write_b32 a25, v231
    v_accvgpr_write_b32 a26, v232
    v_accvgpr_write_b32 a27, v233
    v_accvgpr_write_b32 a28, v234
    v_accvgpr_write_b32 a29, v235
    v_accvgpr_write_b32 a30, v236
    v_accvgpr_write_b32 a31, v237
    v_accvgpr_write_b32 a84, v221
    v_min_f32 v188, v168, v182
    v_sub_f32 v188, v188, v168
    v_exp_f32 v188, v188
    s_nop 0
    v_mul_f32 v32, v32, v188
    v_mul_f32 v33, v33, v188
    v_mul_f32 v34, v34, v188
    v_mul_f32 v35, v35, v188
    v_mul_f32 v36, v36, v188
    v_mul_f32 v37, v37, v188
    v_mul_f32 v38, v38, v188
    v_mul_f32 v39, v39, v188
    v_mul_f32 v40, v40, v188
    v_mul_f32 v41, v41, v188
    v_mul_f32 v42, v42, v188
    v_mul_f32 v43, v43, v188
    v_mul_f32 v44, v44, v188
    v_mul_f32 v45, v45, v188
    v_mul_f32 v46, v46, v188
    v_mul_f32 v47, v47, v188
    v_accvgpr_read_b32 v222, a32
    v_accvgpr_read_b32 v223, a33
    v_accvgpr_read_b32 v224, a34
    v_accvgpr_read_b32 v225, a35
    v_accvgpr_read_b32 v226, a36
    v_accvgpr_read_b32 v227, a37
    v_accvgpr_read_b32 v228, a38
    v_accvgpr_read_b32 v229, a39
    v_accvgpr_read_b32 v230, a40
    v_accvgpr_read_b32 v231, a41
    v_accvgpr_read_b32 v232, a42
    v_accvgpr_read_b32 v233, a43
    v_accvgpr_read_b32 v234, a44
    v_accvgpr_read_b32 v235, a45
    v_accvgpr_read_b32 v236, a46
    v_accvgpr_read_b32 v237, a47
    v_accvgpr_read_b32 v221, a88
    v_mul_f32 v222, v222, v188
    v_mul_f32 v223, v223, v188
    v_mul_f32 v224, v224, v188
    v_mul_f32 v225, v225, v188
    v_mul_f32 v226, v226, v188
    v_mul_f32 v227, v227, v188
    v_mul_f32 v228, v228, v188
    v_mul_f32 v229, v229, v188
    v_mul_f32 v230, v230, v188
    v_mul_f32 v231, v231, v188
    v_mul_f32 v232, v232, v188
    v_mul_f32 v233, v233, v188
    v_mul_f32 v234, v234, v188
    v_mul_f32 v235, v235, v188
    v_mul_f32 v236, v236, v188
    v_mul_f32 v237, v237, v188
    v_mul_f32 v221, v221, v188
    v_accvgpr_write_b32 a32, v222
    v_accvgpr_write_b32 a33, v223
    v_accvgpr_write_b32 a34, v224
    v_accvgpr_write_b32 a35, v225
    v_accvgpr_write_b32 a36, v226
    v_accvgpr_write_b32 a37, v227
    v_accvgpr_write_b32 a38, v228
    v_accvgpr_write_b32 a39, v229
    v_accvgpr_write_b32 a40, v230
    v_accvgpr_write_b32 a41, v231
    v_accvgpr_write_b32 a42, v232
    v_accvgpr_write_b32 a43, v233
    v_accvgpr_write_b32 a44, v234
    v_accvgpr_write_b32 a45, v235
    v_accvgpr_write_b32 a46, v236
    v_accvgpr_write_b32 a47, v237
    v_accvgpr_write_b32 a88, v221
    v_min_f32 v188, v172, v183
    v_sub_f32 v188, v188, v172
    v_exp_f32 v188, v188
    s_nop 0
    v_mul_f32 v48, v48, v188
    v_mul_f32 v49, v49, v188
    v_mul_f32 v50, v50, v188
    v_mul_f32 v51, v51, v188
    v_mul_f32 v52, v52, v188
    v_mul_f32 v53, v53, v188
    v_mul_f32 v54, v54, v188
    v_mul_f32 v55, v55, v188
    v_mul_f32 v56, v56, v188
    v_mul_f32 v57, v57, v188
    v_mul_f32 v58, v58, v188
    v_mul_f32 v59, v59, v188
    v_mul_f32 v60, v60, v188
    v_mul_f32 v61, v61, v188
    v_mul_f32 v62, v62, v188
    v_mul_f32 v63, v63, v188
    v_accvgpr_read_b32 v222, a48
    v_accvgpr_read_b32 v223, a49
    v_accvgpr_read_b32 v224, a50
    v_accvgpr_read_b32 v225, a51
    v_accvgpr_read_b32 v226, a52
    v_accvgpr_read_b32 v227, a53
    v_accvgpr_read_b32 v228, a54
    v_accvgpr_read_b32 v229, a55
    v_accvgpr_read_b32 v230, a56
    v_accvgpr_read_b32 v231, a57
    v_accvgpr_read_b32 v232, a58
    v_accvgpr_read_b32 v233, a59
    v_accvgpr_read_b32 v234, a60
    v_accvgpr_read_b32 v235, a61
    v_accvgpr_read_b32 v236, a62
    v_accvgpr_read_b32 v237, a63
    v_accvgpr_read_b32 v221, a92
    v_mul_f32 v222, v222, v188
    v_mul_f32 v223, v223, v188
    v_mul_f32 v224, v224, v188
    v_mul_f32 v225, v225, v188
    v_mul_f32 v226, v226, v188
    v_mul_f32 v227, v227, v188
    v_mul_f32 v228, v228, v188
    v_mul_f32 v229, v229, v188
    v_mul_f32 v230, v230, v188
    v_mul_f32 v231, v231, v188
    v_mul_f32 v232, v232, v188
    v_mul_f32 v233, v233, v188
    v_mul_f32 v234, v234, v188
    v_mul_f32 v235, v235, v188
    v_mul_f32 v236, v236, v188
    v_mul_f32 v237, v237, v188
    v_mul_f32 v221, v221, v188
    v_accvgpr_write_b32 a48, v222
    v_accvgpr_write_b32 a49, v223
    v_accvgpr_write_b32 a50, v224
    v_accvgpr_write_b32 a51, v225
    v_accvgpr_write_b32 a52, v226
    v_accvgpr_write_b32 a53, v227
    v_accvgpr_write_b32 a54, v228
    v_accvgpr_write_b32 a55, v229
    v_accvgpr_write_b32 a56, v230
    v_accvgpr_write_b32 a57, v231
    v_accvgpr_write_b32 a58, v232
    v_accvgpr_write_b32 a59, v233
    v_accvgpr_write_b32 a60, v234
    v_accvgpr_write_b32 a61, v235
    v_accvgpr_write_b32 a62, v236
    v_accvgpr_write_b32 a63, v237
    v_accvgpr_write_b32 a92, v221
    v_min_f32 v188, v176, v184
    v_sub_f32 v188, v188, v176
    v_exp_f32 v188, v188
    s_nop 0
    v_mul_f32 v64, v64, v188
    v_mul_f32 v65, v65, v188
    v_mul_f32 v66, v66, v188
    v_mul_f32 v67, v67, v188
    v_mul_f32 v68, v68, v188
    v_mul_f32 v69, v69, v188
    v_mul_f32 v70, v70, v188
    v_mul_f32 v71, v71, v188
    v_mul_f32 v72, v72, v188
    v_mul_f32 v73, v73, v188
    v_mul_f32 v74, v74, v188
    v_mul_f32 v75, v75, v188
    v_mul_f32 v76, v76, v188
    v_mul_f32 v77, v77, v188
    v_mul_f32 v78, v78, v188
    v_mul_f32 v79, v79, v188
    v_accvgpr_read_b32 v222, a64
    v_accvgpr_read_b32 v223, a65
    v_accvgpr_read_b32 v224, a66
    v_accvgpr_read_b32 v225, a67
    v_accvgpr_read_b32 v226, a68
    v_accvgpr_read_b32 v227, a69
    v_accvgpr_read_b32 v228, a70
    v_accvgpr_read_b32 v229, a71
    v_accvgpr_read_b32 v230, a72
    v_accvgpr_read_b32 v231, a73
    v_accvgpr_read_b32 v232, a74
    v_accvgpr_read_b32 v233, a75
    v_accvgpr_read_b32 v234, a76
    v_accvgpr_read_b32 v235, a77
    v_accvgpr_read_b32 v236, a78
    v_accvgpr_read_b32 v237, a79
    v_accvgpr_read_b32 v221, a96
    v_mul_f32 v222, v222, v188
    v_mul_f32 v223, v223, v188
    v_mul_f32 v224, v224, v188
    v_mul_f32 v225, v225, v188
    v_mul_f32 v226, v226, v188
    v_mul_f32 v227, v227, v188
    v_mul_f32 v228, v228, v188
    v_mul_f32 v229, v229, v188
    v_mul_f32 v230, v230, v188
    v_mul_f32 v231, v231, v188
    v_mul_f32 v232, v232, v188
    v_mul_f32 v233, v233, v188
    v_mul_f32 v234, v234, v188
    v_mul_f32 v235, v235, v188
    v_mul_f32 v236, v236, v188
    v_mul_f32 v237, v237, v188
    v_mul_f32 v221, v221, v188
    v_accvgpr_write_b32 a64, v222
    v_accvgpr_write_b32 a65, v223
    v_accvgpr_write_b32 a66, v224
    v_accvgpr_write_b32 a67, v225
    v_accvgpr_write_b32 a68, v226
    v_accvgpr_write_b32 a69, v227
    v_accvgpr_write_b32 a70, v228
    v_accvgpr_write_b32 a71, v229
    v_accvgpr_write_b32 a72, v230
    v_accvgpr_write_b32 a73, v231
    v_accvgpr_write_b32 a74, v232
    v_accvgpr_write_b32 a75, v233
    v_accvgpr_write_b32 a76, v234
    v_accvgpr_write_b32 a77, v235
    v_accvgpr_write_b32 a78, v236
    v_accvgpr_write_b32 a79, v237
    v_accvgpr_write_b32 a96, v221
    s_nop 1
    ds_write_b128 v255, a[0:3] offset:0
    ds_write_b128 v255, a[4:7] offset:1024
    ds_write_b128 v255, a[8:11] offset:2048
    ds_write_b128 v255, a[12:15] offset:3072
    ds_write_b32 v240, a80 offset:0
    ds_write_b128 v255, a[16:19] offset:4096
    ds_write_b128 v255, a[20:23] offset:5120
    ds_write_b128 v255, a[24:27] offset:6144
    ds_write_b128 v255, a[28:31] offset:7168
    ds_write_b32 v240, a84 offset:256
    ds_write_b128 v255, a[32:35] offset:8192
    ds_write_b128 v255, a[36:39] offset:9216
    ds_write_b128 v255, a[40:43] offset:10240
    ds_write_b128 v255, a[44:47] offset:11264
    ds_write_b32 v240, a88 offset:512
    ds_write_b128 v255, a[48:51] offset:12288
    ds_write_b128 v255, a[52:55] offset:13312
    ds_write_b128 v255, a[56:59] offset:14336
    ds_write_b128 v255, a[60:63] offset:15360
    ds_write_b32 v240, a92 offset:768
    ds_write_b128 v255, a[64:67] offset:16384
    ds_write_b128 v255, a[68:71] offset:17408
    ds_write_b128 v255, a[72:75] offset:18432
    ds_write_b128 v255, a[76:79] offset:19456
    ds_write_b32 v240, a96 offset:1024
    v_accvgpr_read_b32 v180, a80
    v_accvgpr_read_b32 v181, a84
    v_accvgpr_read_b32 v182, a88
    v_accvgpr_read_b32 v183, a92
    v_accvgpr_read_b32 v184, a96
    s_waitcnt lgkmcnt(0)
    s_barrier
    ds_read_b32 v188, v241 offset:0
    ds_read_b32 v189, v241 offset:256
    ds_read_b32 v190, v241 offset:512
    ds_read_b32 v191, v241 offset:768
    ds_read_b32 v192, v241 offset:1024
    ds_read_b128 v[80:83], v242 offset:0
    ds_read_b128 v[84:87], v242 offset:1024
    ds_read_b128 v[88:91], v242 offset:2048
    ds_read_b128 v[92:95], v242 offset:3072
    ds_read_b128 v[96:99], v242 offset:4096
    ds_read_b128 v[100:103], v242 offset:5120
    ds_read_b128 v[104:107], v242 offset:6144
    ds_read_b128 v[108:111], v242 offset:7168
    ds_read_b128 v[112:115], v242 offset:8192
    ds_read_b128 v[116:119], v242 offset:9216
    ds_read_b128 v[120:123], v242 offset:10240
    ds_read_b128 v[124:127], v242 offset:11264
    ds_read_b128 v[128:131], v242 offset:12288
    ds_read_b128 v[132:135], v242 offset:13312
    ds_read_b128 v[136:139], v242 offset:14336
    ds_read_b128 v[140:143], v242 offset:15360
    ds_read_b128 v[144:147], v242 offset:16384
    ds_read_b128 v[148:151], v242 offset:17408
    ds_read_b128 v[152:155], v242 offset:18432
    ds_read_b128 v[156:159], v242 offset:19456
    s_waitcnt lgkmcnt(0)
    v_add_f32 v180, v180, v188
    v_add_f32 v181, v181, v189
    v_add_f32 v182, v182, v190
    v_add_f32 v183, v183, v191
    v_add_f32 v184, v184, v192
    v_rcp_f32 v218, v180
    v_rcp_f32 v220, v181
    v_rcp_f32 v222, v182
    v_rcp_f32 v224, v183
    v_rcp_f32 v226, v184
    s_nop 0
    v_pk_add_f32 v[0:1], v[0:1], v[80:81]
    v_pk_add_f32 v[2:3], v[2:3], v[82:83]
    v_pk_add_f32 v[4:5], v[4:5], v[84:85]
    v_pk_add_f32 v[6:7], v[6:7], v[86:87]
    v_pk_add_f32 v[8:9], v[8:9], v[88:89]
    v_pk_add_f32 v[10:11], v[10:11], v[90:91]
    v_pk_add_f32 v[12:13], v[12:13], v[92:93]
    v_pk_add_f32 v[14:15], v[14:15], v[94:95]
    v_pk_mul_f32 v[0:1], v[0:1], v[218:219] op_sel_hi:[1,0]
    v_pk_mul_f32 v[2:3], v[2:3], v[218:219] op_sel_hi:[1,0]
    v_pk_mul_f32 v[4:5], v[4:5], v[218:219] op_sel_hi:[1,0]
    v_pk_mul_f32 v[6:7], v[6:7], v[218:219] op_sel_hi:[1,0]
    v_pk_mul_f32 v[8:9], v[8:9], v[218:219] op_sel_hi:[1,0]
    v_pk_mul_f32 v[10:11], v[10:11], v[218:219] op_sel_hi:[1,0]
    v_pk_mul_f32 v[12:13], v[12:13], v[218:219] op_sel_hi:[1,0]
    v_pk_mul_f32 v[14:15], v[14:15], v[218:219] op_sel_hi:[1,0]
    v_cvt_pk_bf16_f32 v80, v0, v1
    v_cvt_pk_bf16_f32 v81, v2, v3
    v_cvt_pk_bf16_f32 v82, v4, v5
    v_cvt_pk_bf16_f32 v83, v6, v7
    v_cvt_pk_bf16_f32 v88, v8, v9
    v_cvt_pk_bf16_f32 v89, v10, v11
    v_cvt_pk_bf16_f32 v90, v12, v13
    v_cvt_pk_bf16_f32 v91, v14, v15
    s_nop 0
    v_permlane16_swap_b32 v80, v82
    v_permlane16_swap_b32 v81, v83
    v_permlane16_swap_b32 v88, v90
    v_permlane16_swap_b32 v89, v91
    buffer_store_dwordx4 v[80:83], v254, s[24:27], s40 offen offset:0 sc0 sc1
    buffer_store_dwordx4 v[88:91], v254, s[24:27], s40 offen offset:64 sc0 sc1
    v_pk_add_f32 v[16:17], v[16:17], v[96:97]
    v_pk_add_f32 v[18:19], v[18:19], v[98:99]
    v_pk_add_f32 v[20:21], v[20:21], v[100:101]
    v_pk_add_f32 v[22:23], v[22:23], v[102:103]
    v_pk_add_f32 v[24:25], v[24:25], v[104:105]
    v_pk_add_f32 v[26:27], v[26:27], v[106:107]
    v_pk_add_f32 v[28:29], v[28:29], v[108:109]
    v_pk_add_f32 v[30:31], v[30:31], v[110:111]
    v_pk_mul_f32 v[16:17], v[16:17], v[220:221] op_sel_hi:[1,0]
    v_pk_mul_f32 v[18:19], v[18:19], v[220:221] op_sel_hi:[1,0]
    v_pk_mul_f32 v[20:21], v[20:21], v[220:221] op_sel_hi:[1,0]
    v_pk_mul_f32 v[22:23], v[22:23], v[220:221] op_sel_hi:[1,0]
    v_pk_mul_f32 v[24:25], v[24:25], v[220:221] op_sel_hi:[1,0]
    v_pk_mul_f32 v[26:27], v[26:27], v[220:221] op_sel_hi:[1,0]
    v_pk_mul_f32 v[28:29], v[28:29], v[220:221] op_sel_hi:[1,0]
    v_pk_mul_f32 v[30:31], v[30:31], v[220:221] op_sel_hi:[1,0]
    v_cvt_pk_bf16_f32 v96, v16, v17
    v_cvt_pk_bf16_f32 v97, v18, v19
    v_cvt_pk_bf16_f32 v98, v20, v21
    v_cvt_pk_bf16_f32 v99, v22, v23
    v_cvt_pk_bf16_f32 v104, v24, v25
    v_cvt_pk_bf16_f32 v105, v26, v27
    v_cvt_pk_bf16_f32 v106, v28, v29
    v_cvt_pk_bf16_f32 v107, v30, v31
    s_nop 0
    v_permlane16_swap_b32 v96, v98
    v_permlane16_swap_b32 v97, v99
    v_permlane16_swap_b32 v104, v106
    v_permlane16_swap_b32 v105, v107
    buffer_store_dwordx4 v[96:99], v254, s[24:27], s41 offen offset:0 sc0 sc1
    buffer_store_dwordx4 v[104:107], v254, s[24:27], s41 offen offset:64 sc0 sc1
    v_pk_add_f32 v[32:33], v[32:33], v[112:113]
    v_pk_add_f32 v[34:35], v[34:35], v[114:115]
    v_pk_add_f32 v[36:37], v[36:37], v[116:117]
    v_pk_add_f32 v[38:39], v[38:39], v[118:119]
    v_pk_add_f32 v[40:41], v[40:41], v[120:121]
    v_pk_add_f32 v[42:43], v[42:43], v[122:123]
    v_pk_add_f32 v[44:45], v[44:45], v[124:125]
    v_pk_add_f32 v[46:47], v[46:47], v[126:127]
    v_pk_mul_f32 v[32:33], v[32:33], v[222:223] op_sel_hi:[1,0]
    v_pk_mul_f32 v[34:35], v[34:35], v[222:223] op_sel_hi:[1,0]
    v_pk_mul_f32 v[36:37], v[36:37], v[222:223] op_sel_hi:[1,0]
    v_pk_mul_f32 v[38:39], v[38:39], v[222:223] op_sel_hi:[1,0]
    v_pk_mul_f32 v[40:41], v[40:41], v[222:223] op_sel_hi:[1,0]
    v_pk_mul_f32 v[42:43], v[42:43], v[222:223] op_sel_hi:[1,0]
    v_pk_mul_f32 v[44:45], v[44:45], v[222:223] op_sel_hi:[1,0]
    v_pk_mul_f32 v[46:47], v[46:47], v[222:223] op_sel_hi:[1,0]
    v_cvt_pk_bf16_f32 v112, v32, v33
    v_cvt_pk_bf16_f32 v113, v34, v35
    v_cvt_pk_bf16_f32 v114, v36, v37
    v_cvt_pk_bf16_f32 v115, v38, v39
    v_cvt_pk_bf16_f32 v120, v40, v41
    v_cvt_pk_bf16_f32 v121, v42, v43
    v_cvt_pk_bf16_f32 v122, v44, v45
    v_cvt_pk_bf16_f32 v123, v46, v47
    s_nop 0
    v_permlane16_swap_b32 v112, v114
    v_permlane16_swap_b32 v113, v115
    v_permlane16_swap_b32 v120, v122
    v_permlane16_swap_b32 v121, v123
    buffer_store_dwordx4 v[112:115], v254, s[24:27], s42 offen offset:0 sc0 sc1
    buffer_store_dwordx4 v[120:123], v254, s[24:27], s42 offen offset:64 sc0 sc1
    v_pk_add_f32 v[48:49], v[48:49], v[128:129]
    v_pk_add_f32 v[50:51], v[50:51], v[130:131]
    v_pk_add_f32 v[52:53], v[52:53], v[132:133]
    v_pk_add_f32 v[54:55], v[54:55], v[134:135]
    v_pk_add_f32 v[56:57], v[56:57], v[136:137]
    v_pk_add_f32 v[58:59], v[58:59], v[138:139]
    v_pk_add_f32 v[60:61], v[60:61], v[140:141]
    v_pk_add_f32 v[62:63], v[62:63], v[142:143]
    v_pk_mul_f32 v[48:49], v[48:49], v[224:225] op_sel_hi:[1,0]
    v_pk_mul_f32 v[50:51], v[50:51], v[224:225] op_sel_hi:[1,0]
    v_pk_mul_f32 v[52:53], v[52:53], v[224:225] op_sel_hi:[1,0]
    v_pk_mul_f32 v[54:55], v[54:55], v[224:225] op_sel_hi:[1,0]
    v_pk_mul_f32 v[56:57], v[56:57], v[224:225] op_sel_hi:[1,0]
    v_pk_mul_f32 v[58:59], v[58:59], v[224:225] op_sel_hi:[1,0]
    v_pk_mul_f32 v[60:61], v[60:61], v[224:225] op_sel_hi:[1,0]
    v_pk_mul_f32 v[62:63], v[62:63], v[224:225] op_sel_hi:[1,0]
    v_cvt_pk_bf16_f32 v128, v48, v49
    v_cvt_pk_bf16_f32 v129, v50, v51
    v_cvt_pk_bf16_f32 v130, v52, v53
    v_cvt_pk_bf16_f32 v131, v54, v55
    v_cvt_pk_bf16_f32 v136, v56, v57
    v_cvt_pk_bf16_f32 v137, v58, v59
    v_cvt_pk_bf16_f32 v138, v60, v61
    v_cvt_pk_bf16_f32 v139, v62, v63
    s_nop 0
    v_permlane16_swap_b32 v128, v130
    v_permlane16_swap_b32 v129, v131
    v_permlane16_swap_b32 v136, v138
    v_permlane16_swap_b32 v137, v139
    buffer_store_dwordx4 v[128:131], v254, s[24:27], s43 offen offset:0 sc0 sc1
    buffer_store_dwordx4 v[136:139], v254, s[24:27], s43 offen offset:64 sc0 sc1
    v_pk_add_f32 v[64:65], v[64:65], v[144:145]
    v_pk_add_f32 v[66:67], v[66:67], v[146:147]
    v_pk_add_f32 v[68:69], v[68:69], v[148:149]
    v_pk_add_f32 v[70:71], v[70:71], v[150:151]
    v_pk_add_f32 v[72:73], v[72:73], v[152:153]
    v_pk_add_f32 v[74:75], v[74:75], v[154:155]
    v_pk_add_f32 v[76:77], v[76:77], v[156:157]
    v_pk_add_f32 v[78:79], v[78:79], v[158:159]
    v_pk_mul_f32 v[64:65], v[64:65], v[226:227] op_sel_hi:[1,0]
    v_pk_mul_f32 v[66:67], v[66:67], v[226:227] op_sel_hi:[1,0]
    v_pk_mul_f32 v[68:69], v[68:69], v[226:227] op_sel_hi:[1,0]
    v_pk_mul_f32 v[70:71], v[70:71], v[226:227] op_sel_hi:[1,0]
    v_pk_mul_f32 v[72:73], v[72:73], v[226:227] op_sel_hi:[1,0]
    v_pk_mul_f32 v[74:75], v[74:75], v[226:227] op_sel_hi:[1,0]
    v_pk_mul_f32 v[76:77], v[76:77], v[226:227] op_sel_hi:[1,0]
    v_pk_mul_f32 v[78:79], v[78:79], v[226:227] op_sel_hi:[1,0]
    v_cvt_pk_bf16_f32 v144, v64, v65
    v_cvt_pk_bf16_f32 v145, v66, v67
    v_cvt_pk_bf16_f32 v146, v68, v69
    v_cvt_pk_bf16_f32 v147, v70, v71
    v_cvt_pk_bf16_f32 v152, v72, v73
    v_cvt_pk_bf16_f32 v153, v74, v75
    v_cvt_pk_bf16_f32 v154, v76, v77
    v_cvt_pk_bf16_f32 v155, v78, v79
    s_nop 0
    v_permlane16_swap_b32 v144, v146
    v_permlane16_swap_b32 v145, v147
    v_permlane16_swap_b32 v152, v154
    v_permlane16_swap_b32 v153, v155
    buffer_store_dwordx4 v[144:147], v254, s[24:27], s44 offen offset:0 sc0 sc1
    buffer_store_dwordx4 v[152:155], v254, s[24:27], s44 offen offset:64 sc0 sc1
    s_endpgm

.section .rodata,"a"
.p2align 6
.amdhsa_kernel standalone__gqa_softmax__near_ridge_kernel
  .amdhsa_next_free_vgpr 512
  .amdhsa_next_free_sgpr 102
  .amdhsa_accum_offset 256
  .amdhsa_group_segment_fixed_size 0
  .amdhsa_kernarg_size 48
  .amdhsa_user_sgpr_count 2
  .amdhsa_user_sgpr_kernarg_segment_ptr 1
  .amdhsa_system_sgpr_workgroup_id_x 1
  .amdhsa_float_denorm_mode_32 3
.end_amdhsa_kernel
```
